```python
import torch

def _softmax(x, axis=-1):
    return torch.softmax(x, dim=axis)
def _gelu(x):
    return torch.nn.functional.gelu(x, approximate="tanh")
def _silu(x):
    return torch.nn.functional.silu(x)
def _sigmoid(x):
    return torch.sigmoid(x)
def _layernorm(x, axis=-1, eps=1e-5):
    m = x.mean(dim=axis, keepdim=True)
    v = x.var(dim=axis, keepdim=True, unbiased=False)
    return (x - m) / torch.sqrt(v + eps)
def _scatter_add(tgt, idx, src, axis=0):
    return tgt.clone().index_add_(axis, idx, src)
def _segment_sum(src, seg, n):
    out = torch.zeros((n,) + src.shape[1:], dtype=src.dtype)
    return out.index_add_(0, seg, src)
def _pad(x, pw):
    flat = tuple(v for pair in reversed(pw) for v in pair)
    return torch.nn.functional.pad(x, flat)

kernel_name = 'sequential_preLN__sliding_block_cached__geglu_ffn__decode'

def setup_inputs():

    _w = (lambda a: (lambda t: t.to(torch.bfloat16) if t.is_floating_point() else t)(torch.as_tensor(a)))
    def _A_setup():
        B, Sq, D = 1, 1, 448
        Hq, Hkv, Sk, Dh = 16, 8, 16384, 256
        assert Hq % Hkv == 0, (Hq, Hkv)
        return {
            "x": _w((lambda *s: torch.randn(*s, dtype=torch.bfloat16) * 0.05)(B, Sq, D)),
            "k_cache": _w((lambda *s: torch.randn(*s, dtype=torch.bfloat16) * 3.2)(B, Hkv, Sk, Dh)),
            "v_cache": _w((lambda *s: torch.randn(*s, dtype=torch.bfloat16) * 0.4)(B, Hkv, Sk, Dh)),
            "wq": _w((lambda *s: torch.randn(*s, dtype=torch.bfloat16) * 3.2)(D, Hq * Dh) * (D ** -0.5)),
            "wo": _w((lambda *s: torch.randn(*s, dtype=torch.bfloat16) * 0.4)(Hq * Dh, D) * ((Hq * Dh) ** -0.5)),
        }
    _A_in = _A_setup()

    def _B_setup():
        B, S, D, F = 1, 1, 448, 1792
        return {
            "x": _w((lambda *s: torch.randn(*s, dtype=torch.bfloat16) * 0.05)(B, S, D)),
            "w_gate": _w((lambda *s: torch.randn(*s, dtype=torch.bfloat16) * 0.05)(D, F)),
            "w_up": _w((lambda *s: torch.randn(*s, dtype=torch.bfloat16) * 0.05)(D, F)),
            "w_down": _w((lambda *s: torch.randn(*s, dtype=torch.bfloat16) * 0.05)(F, D)),
        }
    _B_in = _B_setup()

    return {
        "A_x": _A_in["x"],
        "A_k_cache": _A_in["k_cache"],
        "A_v_cache": _A_in["v_cache"],
        "A_wq": _A_in["wq"],
        "A_wo": _A_in["wo"],
        "B_x": _B_in["x"],
        "B_w_gate": _B_in["w_gate"],
        "B_w_up": _B_in["w_up"],
        "B_w_down": _B_in["w_down"],
    }

def reference(A_x, A_k_cache, A_v_cache, A_wq, A_wo, B_x, B_w_gate, B_w_up, B_w_down):
    def _A_ref(x, k_cache, v_cache, wq, wo):
        B, Sq, D = x.shape
        Hq, Dh = 16, 256
        Hkv, Sk = k_cache.shape[1], k_cache.shape[2]
        W = min(4096, max(256, Sk // 4))
        rep = Hq // Hkv
        q = (lambda x, *d: x.permute(*d))((x @ wq).reshape(B, Sq, Hq, Dh), 0, 2, 1, 3)
        k = (lambda x, n, axis: torch.repeat_interleave(x, n, dim=axis))(k_cache[:, :, Sk - W:, :], rep, axis=1)
        v = (lambda x, n, axis: torch.repeat_interleave(x, n, dim=axis))(v_cache[:, :, Sk - W:, :], rep, axis=1)
        scores = torch.einsum("bhqd,bhkd->bhqk", q, k) * (Dh ** -0.5)
        p = _softmax(scores, axis=-1)
        o = torch.einsum("bhqk,bhkd->bhqd", p, v)
        return (lambda x, *d: x.permute(*d))(o, 0, 2, 1, 3).reshape(B, Sq, Hq * Dh) @ wo

    def _B_ref(x, w_gate, w_up, w_down):
        return (_gelu(x @ w_gate) * (x @ w_up)) @ w_down

    x = A_x
    h = x + _A_ref(_layernorm(x, axis=-1), A_k_cache, A_v_cache, A_wq, A_wo)
    h2 = h + _B_ref(_layernorm(h, axis=-1), B_w_gate, B_w_up, B_w_down)
    return h2
```

```asm
; @launch grid=(256,1,1) block=(512,1,1) lds=47616
.amdgcn_target "amdgcn-amd-amdhsa--gfx950"
.text
.globl sequential_preLN__sliding_block_cached__geglu_ffn__decode_kernel
.p2align 12
.p2align 8
.type sequential_preLN__sliding_block_cached__geglu_ffn__decode_kernel,@function
sequential_preLN__sliding_block_cached__geglu_ffn__decode_kernel:
    s_load_dwordx2 s[8:9], s[0:1], 8
    s_load_dwordx2 s[36:37], s[0:1], 0
    s_load_dwordx2 s[16:17], s[0:1], 24
    s_load_dwordx2 s[12:13], s[0:1], 16
    s_load_dwordx2 s[20:21], s[0:1], 88
    s_cmp_ge_u32 s2, 256
    s_cbranch_scc1 L_end
    v_lshrrev_b32 v3, 6, v0
    v_and_b32 v1, 63, v0
    s_and_b32 s3, s2, 7
    v_readfirstlane_b32 s5, v3
    s_lshr_b32 s4, s2, 3
    s_and_b32 s55, s5, 3
    s_add_u32 s31, s4, 2
    s_lshr_b32 s31, s31, 4
    s_cmp_lg_u32 s31, 0
    s_cselect_b32 s7, 4, 0
    s_xor_b32 s5, s5, s7
    s_cmp_ge_u32 s5, 4
    s_cbranch_scc1 L_v0
    s_getpc_b64 s[46:47]
L_pc:
    s_lshl2_add_u32 s7, s4, s55
    s_lshl_b32 s7, s7, 7
    s_addk_i32 s7, 0x300
    s_min_u32 s7, s7, L_end-L_pc
    s_add_u32 s46, s46, s7
    s_addc_u32 s47, s47, 0
    v_mov_b32 v10, s46
    v_mov_b32 v11, s47
    global_load_dword v216, v[10:11], off
    v_and_b32 v10, 7, v1
    v_lshrrev_b32 v11, 3, v1
    v_lshlrev_b32 v10, 4, v10
    v_lshl_add_u32 v2, v11, 9, v10
    s_lshl_b32 s7, s3, 7
    s_add_u32 s7, s7, s4
    s_add_u32 s7, s7, 96
    s_lshl_b32 s44, s7, 4
    s_and_b32 s7, s4, 15
    s_or_b32 s44, s44, s7
    s_mov_b32 s10, 0x4000000
    s_mov_b32 s11, 0x20000
    s_xor_b32 s45, s44, s55
    s_lshl_b32 s45, s45, 12
    v_and_b32 v10, 0xfc, v0
    v_mov_b32 v11, 0
    ds_write_b32 v10, v11 offset:8448
    s_cmp_lg_u32 s31, 0
    s_waitcnt lgkmcnt(0)
    s_load_dword s6, s[20:21], 0
    s_cbranch_scc0 L_k1
    s_barrier
L_k1:
    buffer_load_dwordx4 v[16:19], v2, s[8:11], s45 offen offset:0 nt
    buffer_load_dwordx4 v[20:23], v2, s[8:11], s45 offen offset:128 nt
    buffer_load_dwordx4 v[24:27], v2, s[8:11], s45 offen offset:256 nt
    buffer_load_dwordx4 v[28:31], v2, s[8:11], s45 offen offset:384 nt
    s_xor_b32 s45, s45, 0x4000
    buffer_load_dwordx4 v[32:35], v2, s[8:11], s45 offen offset:0 nt
    buffer_load_dwordx4 v[36:39], v2, s[8:11], s45 offen offset:128 nt
    s_cmp_lg_u32 s31, 0
    s_cbranch_scc1 L_kb
    s_barrier
    s_branch L_kb
L_v0:
    s_cmp_lg_u32 s31, 0
    s_cbranch_scc1 L_qw
    s_waitcnt lgkmcnt(0)
    s_load_dword s6, s[20:21], 0
    s_barrier
    s_branch L_v
L_qw:
    s_mov_b32 s18, 0x380000
    s_mov_b32 s19, 0x20000
    s_mov_b32 s38, 0x380
    s_mov_b32 s39, 0x20000
    v_lshlrev_b32 v8, 4, v1
    v_lshrrev_b32 v12, 3, v1
    v_mul_u32_u24 v3, 229376, v12
    v_and_b32 v10, 0x70, v8
    v_add_u32 v3, v3, v10
    s_bfe_u32 s54, s4, 0x30001
    s_cmp_eq_u32 s54, 3
    s_cselect_b32 vcc_hi, 0, -1
    s_cmp_ge_u32 s4, 16
    s_cselect_b32 vcc_lo, -1, 0
    s_cselect_b32 s54, s54, 3
    s_lshl3_add_u32 s54, s3, s54
    v_cndmask_b32 v3, 2.0, v3, vcc
    s_and_b32 s44, s4, 1
    s_lshl_b32 s44, s44, 5
    s_add_u32 s44, s44, s55
    s_mul_i32 s45, s44, 448
    s_add_u32 s45, s45, s54
    s_lshl_b32 s45, s45, 7
    s_movk_i32 s46, 0x2000
    s_waitcnt lgkmcnt(0)
    buffer_load_dwordx4 v[192:195], v8, s[36:39], 0 offen
    s_load_dword s6, s[20:21], 0
    buffer_load_dwordx4 v[16:19], v3, s[16:19], s45 offen nt
    s_add_u32 s45, s45, s46
    buffer_load_dwordx4 v[20:23], v3, s[16:19], s45 offen nt
    s_add_u32 s45, s45, s46
    buffer_load_dwordx4 v[24:27], v3, s[16:19], s45 offen nt
    s_add_u32 s45, s45, s46
    buffer_load_dwordx4 v[28:31], v3, s[16:19], s45 offen nt
    s_add_u32 s45, s45, s46
    buffer_load_dwordx4 v[32:35], v3, s[16:19], s45 offen nt
    s_add_u32 s45, s45, s46
    buffer_load_dwordx4 v[36:39], v3, s[16:19], s45 offen nt
    s_add_u32 s45, s45, s46
    buffer_load_dwordx4 v[40:43], v3, s[16:19], s45 offen nt
    s_barrier
    s_load_dwordx2 s[24:25], s[0:1], 48
    s_load_dwordx2 s[28:29], s[0:1], 56
    s_load_dwordx2 s[32:33], s[0:1], 64
    s_load_dwordx2 s[40:41], s[0:1], 72
    s_mov_b32 s22, 0x10000000
    s_mov_b32 s23, 0x20000
    s_mov_b32 s26, 0x188000
    s_mov_b32 s27, 0x20000
    s_mov_b32 s34, 0x188000
    s_mov_b32 s35, 0x20000
    s_mov_b32 s42, 0x380
    s_mov_b32 s43, 0x20000
    s_mov_b32 s48, 0x07060501
    s_mov_b32 s49, 0x07060502
    s_mov_b32 s50, 0x07060503
    s_mov_b32 s51, 0x0c04000c
    s_mov_b32 s52, 0x04020100
    v_and_b32 v10, 1, v1
    v_lshlrev_b32 v10, 4, v10
    s_mov_b32 s7, 0xffff
    v_lshlrev_b32_e64 v10, v10, s7
    v_bfe_u32 v11, v1, 1, 2
    v_cmp_eq_u32 vcc, 0, v11
    s_nop 1
    v_cndmask_b32 v4, 0, v10, vcc
    v_cmp_eq_u32 vcc, 1, v11
    s_nop 1
    v_cndmask_b32 v5, 0, v10, vcc
    v_cmp_eq_u32 vcc, 2, v11
    s_nop 1
    v_cndmask_b32 v6, 0, v10, vcc
    v_cmp_eq_u32 vcc, 3, v11
    s_nop 1
    v_cndmask_b32 v7, 0, v10, vcc
    v_lshlrev_b32 v8, 4, v1
    v_mov_b32 v196, 0
    v_mov_b32 v197, 0
    v_mov_b32 v198, 0x3f803f80
    v_mov_b32 v199, 0x3b124925
    v_lshlrev_b32 v13, 5, v1
    v_mul_u32_u24 v14, 112, v12
    s_mul_i32 s7, s44, 28
    s_add_u32 s7, s7, 6400
    v_add_u32 v14, s7, v14
    v_lshl_add_u32 v15, s55, 3, v13
    v_and_b32 v10, 3, v1
    v_lshlrev_b32 v217, 2, v10
    v_lshlrev_b32_e64 v221, 2, s55
    v_mov_b32 v220, 1
    v_and_b32 v10, 7, v1
    v_lshlrev_b32 v10, 6, v10
    v_bfe_u32 v11, v1, 4, 1
    v_lshl_add_u32 v10, v11, 5, v10
    v_lshrrev_b32 v11, 5, v1
    v_lshl_add_u32 v9, v11, 4, v10
    s_lshr_b32 s7, s54, 1
    s_and_b32 s44, s4, 1
    s_lshl1_add_u32 s7, s7, s44
    s_and_b32 s45, s54, 1
    s_lshl1_add_u32 s7, s7, s45
    s_lshl1_add_u32 s45, s3, s44
    s_add_u32 s45, s45, 0x300
    s_cmp_ge_u32 s4, 16
    s_cselect_b32 s7, s7, s45
    s_lshl_b32 s57, s7, 9
    s_add_u32 s57, s57, 0x180000
    s_lshl_b32 s7, s55, 1
    s_lshl_b32 s58, 0x00030003, s7
    s_mov_b32 s59, s58
    s_waitcnt vmcnt(7)
    v_dot2c_f32_bf16 v196, v192, v198
    v_dot2c_f32_bf16 v197, v192, v192
    v_dot2c_f32_bf16 v196, v193, v198
    v_dot2c_f32_bf16 v197, v193, v193
    v_dot2c_f32_bf16 v196, v194, v198
    v_dot2c_f32_bf16 v197, v194, v194
    v_dot2c_f32_bf16 v196, v195, v198
    v_dot2c_f32_bf16 v197, v195, v195
    v_and_b32 v207, 0xffff0000, v195
    v_lshlrev_b32 v206, 16, v195
    v_add_f32_dpp v196, v196, v196 quad_perm:[1,0,3,2] row_mask:0xf bank_mask:0xf
    v_add_f32_dpp v197, v197, v197 quad_perm:[1,0,3,2] row_mask:0xf bank_mask:0xf
    v_and_b32 v205, 0xffff0000, v194
    v_add_f32_dpp v196, v196, v196 quad_perm:[2,3,0,1] row_mask:0xf bank_mask:0xf
    v_add_f32_dpp v197, v197, v197 quad_perm:[2,3,0,1] row_mask:0xf bank_mask:0xf
    v_lshlrev_b32 v204, 16, v194
    v_add_f32_dpp v196, v196, v196 row_half_mirror row_mask:0xf bank_mask:0xf
    v_add_f32_dpp v197, v197, v197 row_half_mirror row_mask:0xf bank_mask:0xf
    v_and_b32 v203, 0xffff0000, v193
    v_add_f32_dpp v196, v196, v196 row_mirror row_mask:0xf bank_mask:0xf
    v_add_f32_dpp v197, v197, v197 row_mirror row_mask:0xf bank_mask:0xf
    v_lshlrev_b32 v202, 16, v193
    v_add_f32_dpp v196, v196, v196 row_bcast:15 row_mask:0xa bank_mask:0xf
    v_add_f32_dpp v197, v197, v197 row_bcast:15 row_mask:0xa bank_mask:0xf
    v_and_b32 v201, 0xffff0000, v192
    v_add_f32_dpp v196, v196, v196 row_bcast:31 row_mask:0xc bank_mask:0xf
    v_add_f32_dpp v197, v197, v197 row_bcast:31 row_mask:0xc bank_mask:0xf
    v_lshlrev_b32 v200, 16, v192
    v_readlane_b32 s62, v196, 63
    v_readlane_b32 s63, v197, 63
    s_nop 0
    v_mul_f32 v196, s62, v199
    v_mul_f32 v197, s63, v199
    v_fma_f32 v197, -v196, v196, v197
    v_cvt_pk_bf16_f32 v196, 0, v196
    v_max_f32 v197, 0, v197
    v_cvt_pk_bf16_f32 v197, 0, v197
    v_add_f32 v197, 0x3727c5ac, v197
    v_cvt_pk_bf16_f32 v197, 0, v197
    v_sqrt_f32 v197, v197
    v_sub_f32 v200, v200, v196
    v_sub_f32 v201, v201, v196
    v_sub_f32 v202, v202, v196
    v_sub_f32 v203, v203, v196
    v_sub_f32 v204, v204, v196
    v_sub_f32 v205, v205, v196
    v_sub_f32 v206, v206, v196
    v_sub_f32 v207, v207, v196
    v_cvt_pk_bf16_f32 v197, 0, v197
    v_rcp_f32 v197, v197
    v_cvt_pk_bf16_f32 v200, 0, v200
    v_cvt_pk_bf16_f32 v201, 0, v201
    v_cvt_pk_bf16_f32 v202, 0, v202
    v_cvt_pk_bf16_f32 v203, 0, v203
    v_cvt_pk_bf16_f32 v204, 0, v204
    v_cvt_pk_bf16_f32 v205, 0, v205
    v_cvt_pk_bf16_f32 v206, 0, v206
    v_cvt_pk_bf16_f32 v207, 0, v207
    v_mul_f32 v200, v200, v197
    v_mul_f32 v201, v201, v197
    v_mul_f32 v202, v202, v197
    v_mul_f32 v203, v203, v197
    v_mul_f32 v204, v204, v197
    v_mul_f32 v205, v205, v197
    v_mul_f32 v206, v206, v197
    v_mul_f32 v207, v207, v197
    v_cvt_pk_bf16_f32 v200, v200, v200
    v_cvt_pk_bf16_f32 v201, v201, v201
    v_cvt_pk_bf16_f32 v202, v202, v202
    v_cvt_pk_bf16_f32 v203, v203, v203
    v_cvt_pk_bf16_f32 v204, v204, v204
    v_cvt_pk_bf16_f32 v205, v205, v205
    v_cvt_pk_bf16_f32 v206, v206, v206
    v_cvt_pk_bf16_f32 v207, v207, v207
    ds_write_b128 v13, v[200:203] offset:6400
    ds_write_b128 v13, v[204:207] offset:6416
    s_waitcnt lgkmcnt(0)
    ds_read2_b32 v[128:129], v14 offset0:0 offset1:1
    ds_read2_b32 v[130:131], v14 offset0:2 offset1:3
    ds_read2_b32 v[132:133], v14 offset0:4 offset1:5
    ds_read_b32 v134, v14 offset:24
    s_mul_i32 s6, s6, 0x9e3779b1
    s_add_u32 s6, s6, 0x7f4a7c15
    v_mov_b32 v214, s6
    v_mov_b32 v215, s6
    s_lshl_b32 s7, s3, 5
    s_add_u32 s7, s7, s4
    s_lshl_b32 s7, s7, 7
    s_add_u32 s47, s7, 0x4000
    s_getreg_b32 s7, hwreg(HW_REG_XCC_ID, 0, 4)
    v_mov_b32 v222, s7
    v_mov_b32 v223, s6
    s_waitcnt lgkmcnt(0)
    v_and_b32 v192, v128, v4
    v_and_b32 v193, v128, v5
    v_and_b32 v194, v128, v6
    v_and_b32 v195, v128, v7
    v_and_b32 v196, v129, v4
    v_and_b32 v197, v129, v5
    v_and_b32 v198, v129, v6
    v_and_b32 v199, v129, v7
    s_waitcnt vmcnt(6)
    v_mfma_f32_16x16x32_bf16 v[208:211], v[192:195], v[16:19], 0
    v_and_b32 v192, v130, v4
    v_and_b32 v193, v130, v5
    v_and_b32 v194, v130, v6
    v_and_b32 v195, v130, v7
    s_waitcnt vmcnt(5)
    v_mfma_f32_16x16x32_bf16 v[208:211], v[196:199], v[20:23], v[208:211]
    v_and_b32 v196, v131, v4
    v_and_b32 v197, v131, v5
    v_and_b32 v198, v131, v6
    v_and_b32 v199, v131, v7
    s_waitcnt vmcnt(4)
    v_mfma_f32_16x16x32_bf16 v[208:211], v[192:195], v[24:27], v[208:211]
    v_and_b32 v192, v132, v4
    v_and_b32 v193, v132, v5
    v_and_b32 v194, v132, v6
    v_and_b32 v195, v132, v7
    s_waitcnt vmcnt(3)
    v_mfma_f32_16x16x32_bf16 v[208:211], v[196:199], v[28:31], v[208:211]
    v_and_b32 v196, v133, v4
    v_and_b32 v197, v133, v5
    v_and_b32 v198, v133, v6
    v_and_b32 v199, v133, v7
    s_waitcnt vmcnt(2)
    v_mfma_f32_16x16x32_bf16 v[208:211], v[192:195], v[32:35], v[208:211]
    v_and_b32 v192, v134, v4
    v_and_b32 v193, v134, v5
    v_and_b32 v194, v134, v6
    v_and_b32 v195, v134, v7
    s_waitcnt vmcnt(1)
    v_mfma_f32_16x16x32_bf16 v[208:211], v[196:199], v[36:39], v[208:211]
    s_waitcnt vmcnt(0)
    v_mfma_f32_16x16x32_bf16 v[208:211], v[192:195], v[40:43], v[208:211]
    s_nop 7
    v_mov_b32_dpp v208, v208 row_ror:8 row_mask:0xc bank_mask:0xf
    v_mov_b32_dpp v209, v209 row_ror:8 row_mask:0xc bank_mask:0xf
    v_mov_b32_dpp v210, v210 row_ror:8 row_mask:0xc bank_mask:0xf
    v_mov_b32_dpp v211, v211 row_ror:8 row_mask:0xc bank_mask:0xf
    s_nop 0
    v_permlane32_swap_b32 v208, v210
    v_permlane32_swap_b32 v209, v211
    v_pk_add_f32 v[208:209], v[208:209], v[210:211]
    ds_write_b64 v15, v[208:209] offset:14848
    ds_write_b32 v221, v220 offset:8544
    s_cmp_eq_u32 s5, 6
    s_cbranch_scc0 L_xp9
    s_mov_b64 exec, 1
    buffer_store_dwordx2 v[222:223], off, s[20:23], s47
    s_mov_b64 exec, -1
L_xp9:
L_gate10:
    ds_read_b32 v219, v217 offset:8544
    s_waitcnt lgkmcnt(0)
    v_cmp_ne_u32 vcc, 1, v219
    s_cbranch_vccnz L_gate10
    ds_read_b128 v[192:195], v13 offset:14848
    ds_read_b128 v[196:199], v13 offset:14864
    s_waitcnt lgkmcnt(0)
    v_pk_add_f32 v[192:193], v[192:193], v[194:195]
    v_pk_add_f32 v[196:197], v[196:197], v[198:199]
    v_pk_add_f32 v[212:213], v[192:193], v[196:197]
    s_mov_b64 exec, s[58:59]
    buffer_store_dwordx4 v[212:215], v9, s[20:23], s57 offen
    s_add_u32 s100, s57, 0x10000
    ds_write_b32 v221, v220 offset:8576
    s_mov_b64 exec, -1
    s_mov_b64 s[98:99], s[58:59]
    v_mov_b32 v211, v9
    s_branch L_v3
L_kb:
    s_mov_b32 s38, 0x380
    s_mov_b32 s39, 0x20000
    s_load_dwordx2 s[24:25], s[0:1], 48
    s_load_dwordx2 s[28:29], s[0:1], 56
    s_load_dwordx2 s[32:33], s[0:1], 64
    s_load_dwordx2 s[40:41], s[0:1], 72
    s_mov_b32 s22, 0x10000000
    s_mov_b32 s23, 0x20000
    s_mov_b32 s26, 0x188000
    s_mov_b32 s27, 0x20000
    s_mov_b32 s34, 0x188000
    s_mov_b32 s35, 0x20000
    s_mov_b32 s42, 0x380
    s_mov_b32 s43, 0x20000
    s_mov_b32 s48, 0x07060501
    s_mov_b32 s49, 0x07060502
    s_mov_b32 s50, 0x07060503
    s_mov_b32 s51, 0x0c04000c
    s_mov_b32 s52, 0x04020100
    v_and_b32 v10, 1, v1
    v_lshlrev_b32 v10, 4, v10
    s_mov_b32 s7, 0xffff
    v_lshlrev_b32_e64 v10, v10, s7
    v_bfe_u32 v11, v1, 1, 2
    v_cmp_eq_u32 vcc, 0, v11
    s_nop 1
    v_cndmask_b32 v4, 0, v10, vcc
    v_cmp_eq_u32 vcc, 1, v11
    s_nop 1
    v_cndmask_b32 v5, 0, v10, vcc
    v_cmp_eq_u32 vcc, 2, v11
    s_nop 1
    v_cndmask_b32 v6, 0, v10, vcc
    v_cmp_eq_u32 vcc, 3, v11
    s_nop 1
    v_cndmask_b32 v7, 0, v10, vcc
    v_lshlrev_b32 v8, 4, v1
    v_mov_b32 v200, 0
    v_mov_b32 v201, 0
    v_mov_b32 v202, 0
    v_mov_b32 v203, 0
    v_mov_b32 v204, 0
    v_mov_b32 v205, 0
    v_mov_b32 v206, 0
    v_mov_b32 v207, 0
    v_mov_b32 v208, 0
    v_mov_b32 v209, 0
    v_mov_b32 v212, 0
    v_mov_b32 v213, 0
    s_mul_i32 s7, s3, -7168
    s_add_u32 s7, s7, 0x5f800
    v_add_u32 v14, s7, v8
    v_bfe_u32 v10, v1, 2, 1
    v_lshlrev_b32 v10, 9, v10
    v_lshrrev_b32 v12, 4, v1
    v_lshl_add_u32 v10, v12, 7, v10
    v_and_b32 v11, 3, v1
    v_lshlrev_b32 v217, 2, v11
    v_lshl_add_u32 v10, v11, 5, v10
    v_bfe_u32 v11, v1, 3, 1
    v_lshl_add_u32 v10, v11, 2, v10
    v_lshl_add_u32 v13, s55, 3, v10
    v_and_b32 v10, 31, v1
    v_lshlrev_b32 v218, 7, v10
    v_lshlrev_b32_e64 v221, 2, s55
    v_mov_b32 v220, 1
    v_and_b32 v9, 0x70, v8
    v_and_b32 v12, 0xff, v0
    v_lshlrev_b32 v12, 2, v12
    s_lshl_b32 s46, s3, 12
    s_add_u32 s46, s46, 0x4000
    s_getreg_b32 s44, hwreg(HW_REG_XCC_ID, 0, 4)
    s_lshl2_add_u32 s7, s3, s5
    s_lshl_b32 s7, s7, 11
    s_add_u32 s56, s7, 0x180000
    s_mov_b32 s57, 0x10000
    s_mov_b32 s58, 0xaaaaaaaa
    s_mov_b32 s59, 0xaaaaaaaa
    s_mov_b32 s60, 0xcccccccc
    s_mov_b32 s61, 0xcccccccc
    s_mov_b32 s53, 0x3db8aa3b
    s_waitcnt vmcnt(5)
    buffer_load_dwordx4 v[40:43], v2, s[8:11], s45 offen offset:256 nt
    s_waitcnt vmcnt(5)
    buffer_load_dwordx4 v[44:47], v2, s[8:11], s45 offen offset:384 nt
    s_xor_b32 s45, s45, 0xc000
    s_waitcnt vmcnt(5)
    buffer_load_dwordx4 v[48:51], v2, s[8:11], s45 offen offset:0 nt
    s_waitcnt vmcnt(5)
    buffer_load_dwordx4 v[52:55], v2, s[8:11], s45 offen offset:128 nt
    s_waitcnt vmcnt(5)
    buffer_load_dwordx4 v[56:59], v2, s[8:11], s45 offen offset:256 nt
    s_waitcnt vmcnt(5)
    buffer_load_dwordx4 v[60:63], v2, s[8:11], s45 offen offset:384 nt
    s_xor_b32 s45, s45, 0x4000
    s_waitcnt vmcnt(5)
    buffer_load_dwordx4 v[64:67], v2, s[8:11], s45 offen offset:0 nt
    s_waitcnt vmcnt(5)
    buffer_load_dwordx4 v[68:71], v2, s[8:11], s45 offen offset:128 nt
    s_waitcnt vmcnt(5)
    buffer_load_dwordx4 v[72:75], v2, s[8:11], s45 offen offset:256 nt
    s_waitcnt vmcnt(5)
    buffer_load_dwordx4 v[76:79], v2, s[8:11], s45 offen offset:384 nt
    ds_write_b32 v221, v220 offset:8448
    s_cmp_eq_u32 s5, 1
    s_cbranch_scc0 L_k6
    buffer_load_dwordx4 v[208:211], v14, s[20:23], s56 offen sc1 nt
L_k6:
    buffer_load_dwordx4 v[192:195], v8, s[20:23], s56 offen offset:0 sc1 nt
    buffer_load_dwordx4 v[196:199], v8, s[20:23], s56 offen offset:1024 sc1 nt
    s_waitcnt lgkmcnt(0)
    s_mul_i32 s6, s6, 0x9e3779b1
    s_add_u32 s6, s6, 0x7f4a7c15
    s_cmp_eq_u32 s5, 1
    s_cbranch_scc1 L_k7
    v_mov_b32 v211, s6
L_k7:
    s_load_dwordx2 s[16:17], s[0:1], 32
    s_mov_b32 s18, 0x380000
    s_mov_b32 s19, 0x20000
    v_bfe_u32 v10, v1, 3, 2
    v_lshrrev_b32 v11, 5, v1
    v_lshl_add_u32 v10, v10, 1, v11
    v_bfe_u32 v11, v1, 3, 2
    v_lshlrev_b32 v11, 1, v11
    v_xor_b32 v11, v11, v1
    v_and_b32 v11, 7, v11
    v_mul_u32_u24 v10, 3584, v10
    v_lshl_add_u32 v2, v11, 4, v10
    s_cmp_ge_u32 s4, 7
    s_cselect_b32 s54, 1, 0
    s_lshl1_add_u32 s7, s3, s54
    s_lshl_b32 s7, s7, 8
    s_add_u32 s7, s7, s55
    s_sub_u32 s7, s7, s54
    s_mul_i32 s7, s7, 7
    s_add_u32 s7, s7, s4
    s_lshl_b32 s10, s7, 7
    s_lshl_b32 s7, s55, 10
    s_add_u32 m0, s7, 14848
    s_movk_i32 s11, 28672
    s_waitcnt vmcnt(0)
    ds_write_b32 v221, v220 offset:8464
    s_mov_b32 s7, 0
L_pq_chk:
    v_cmp_ne_u32 vcc, s6, v195
    v_cmp_ne_u32_e64 s[96:97], s6, v199
    v_cmp_ne_u32_e64 s[98:99], s6, v211
    s_or_b64 s[62:63], vcc, s[96:97]
    s_or_b64 s[62:63], s[62:63], s[98:99]
    s_cbranch_scc1 L_pq_retry
L_pq_ok:
    v_pk_add_f32 v[192:193], v[192:193], v[196:197]
    v_permlane32_swap_b32 v212, v208
    v_permlane32_swap_b32 v213, v209
    v_pk_add_f32 v[208:209], v[208:209], v[212:213]
    v_pk_add_f32 v[192:193], v[192:193], v[208:209]
    v_cvt_pk_bf16_f32 v192, v192, v193
    ds_write_b32 v12, v192 offset:0
    ds_write_b32 v221, v220 offset:8480
L_gate1:
    ds_read_b32 v219, v217 offset:8480
    s_waitcnt lgkmcnt(0)
    v_cmp_ne_u32 vcc, 1, v219
    s_cbranch_vccnz L_gate1
    ds_read_b128 v[144:147], v9 offset:0
    ds_read_b128 v[148:151], v9 offset:128
    ds_read_b128 v[152:155], v9 offset:256
    ds_read_b128 v[156:159], v9 offset:384
    ds_read_b128 v[160:163], v9 offset:512
    ds_read_b128 v[164:167], v9 offset:640
    ds_read_b128 v[168:171], v9 offset:768
    ds_read_b128 v[172:175], v9 offset:896
    s_waitcnt lgkmcnt(0)
    v_dot2c_f32_bf16 v200, v16, v144
    v_dot2c_f32_bf16 v204, v16, v160
    v_dot2c_f32_bf16 v200, v17, v145
    v_dot2c_f32_bf16 v204, v17, v161
    v_dot2c_f32_bf16 v200, v18, v146
    v_dot2c_f32_bf16 v204, v18, v162
    v_dot2c_f32_bf16 v200, v19, v147
    v_dot2c_f32_bf16 v204, v19, v163
    v_dot2c_f32_bf16 v200, v20, v148
    v_dot2c_f32_bf16 v204, v20, v164
    v_dot2c_f32_bf16 v200, v21, v149
    v_dot2c_f32_bf16 v204, v21, v165
    v_dot2c_f32_bf16 v200, v22, v150
    v_dot2c_f32_bf16 v204, v22, v166
    v_dot2c_f32_bf16 v200, v23, v151
    v_dot2c_f32_bf16 v204, v23, v167
    v_dot2c_f32_bf16 v200, v24, v152
    v_dot2c_f32_bf16 v204, v24, v168
    v_dot2c_f32_bf16 v200, v25, v153
    v_dot2c_f32_bf16 v204, v25, v169
    v_dot2c_f32_bf16 v200, v26, v154
    v_dot2c_f32_bf16 v204, v26, v170
    v_dot2c_f32_bf16 v200, v27, v155
    v_dot2c_f32_bf16 v204, v27, v171
    v_dot2c_f32_bf16 v200, v28, v156
    v_dot2c_f32_bf16 v204, v28, v172
    v_dot2c_f32_bf16 v200, v29, v157
    v_dot2c_f32_bf16 v204, v29, v173
    v_dot2c_f32_bf16 v200, v30, v158
    v_dot2c_f32_bf16 v204, v30, v174
    v_dot2c_f32_bf16 v200, v31, v159
    v_dot2c_f32_bf16 v204, v31, v175
    v_dot2c_f32_bf16 v201, v32, v144
    v_dot2c_f32_bf16 v205, v32, v160
    v_dot2c_f32_bf16 v201, v33, v145
    v_dot2c_f32_bf16 v205, v33, v161
    v_dot2c_f32_bf16 v201, v34, v146
    v_dot2c_f32_bf16 v205, v34, v162
    v_dot2c_f32_bf16 v201, v35, v147
    v_dot2c_f32_bf16 v205, v35, v163
    v_dot2c_f32_bf16 v201, v36, v148
    v_dot2c_f32_bf16 v205, v36, v164
    v_dot2c_f32_bf16 v201, v37, v149
    v_dot2c_f32_bf16 v205, v37, v165
    v_dot2c_f32_bf16 v201, v38, v150
    v_dot2c_f32_bf16 v205, v38, v166
    v_dot2c_f32_bf16 v201, v39, v151
    v_dot2c_f32_bf16 v205, v39, v167
    v_dot2c_f32_bf16 v201, v40, v152
    v_dot2c_f32_bf16 v205, v40, v168
    v_dot2c_f32_bf16 v201, v41, v153
    v_dot2c_f32_bf16 v205, v41, v169
    v_dot2c_f32_bf16 v201, v42, v154
    v_dot2c_f32_bf16 v205, v42, v170
    v_dot2c_f32_bf16 v201, v43, v155
    v_dot2c_f32_bf16 v205, v43, v171
    v_dot2c_f32_bf16 v201, v44, v156
    v_dot2c_f32_bf16 v205, v44, v172
    v_dot2c_f32_bf16 v201, v45, v157
    v_dot2c_f32_bf16 v205, v45, v173
    v_dot2c_f32_bf16 v201, v46, v158
    v_dot2c_f32_bf16 v205, v46, v174
    v_dot2c_f32_bf16 v201, v47, v159
    v_dot2c_f32_bf16 v205, v47, v175
    v_dot2c_f32_bf16 v202, v48, v144
    v_dot2c_f32_bf16 v206, v48, v160
    v_dot2c_f32_bf16 v202, v49, v145
    v_dot2c_f32_bf16 v206, v49, v161
    v_dot2c_f32_bf16 v202, v50, v146
    v_dot2c_f32_bf16 v206, v50, v162
    v_dot2c_f32_bf16 v202, v51, v147
    v_dot2c_f32_bf16 v206, v51, v163
    v_dot2c_f32_bf16 v202, v52, v148
    v_dot2c_f32_bf16 v206, v52, v164
    v_dot2c_f32_bf16 v202, v53, v149
    v_dot2c_f32_bf16 v206, v53, v165
    v_dot2c_f32_bf16 v202, v54, v150
    v_dot2c_f32_bf16 v206, v54, v166
    v_dot2c_f32_bf16 v202, v55, v151
    v_dot2c_f32_bf16 v206, v55, v167
    v_dot2c_f32_bf16 v202, v56, v152
    v_dot2c_f32_bf16 v206, v56, v168
    v_dot2c_f32_bf16 v202, v57, v153
    v_dot2c_f32_bf16 v206, v57, v169
    v_dot2c_f32_bf16 v202, v58, v154
    v_dot2c_f32_bf16 v206, v58, v170
    v_dot2c_f32_bf16 v202, v59, v155
    v_dot2c_f32_bf16 v206, v59, v171
    v_dot2c_f32_bf16 v202, v60, v156
    v_dot2c_f32_bf16 v206, v60, v172
    v_dot2c_f32_bf16 v202, v61, v157
    v_dot2c_f32_bf16 v206, v61, v173
    v_dot2c_f32_bf16 v202, v62, v158
    v_dot2c_f32_bf16 v206, v62, v174
    v_dot2c_f32_bf16 v202, v63, v159
    v_dot2c_f32_bf16 v206, v63, v175
    v_dot2c_f32_bf16 v203, v64, v144
    v_dot2c_f32_bf16 v207, v64, v160
    v_dot2c_f32_bf16 v203, v65, v145
    v_dot2c_f32_bf16 v207, v65, v161
    v_dot2c_f32_bf16 v203, v66, v146
    v_dot2c_f32_bf16 v207, v66, v162
    v_dot2c_f32_bf16 v203, v67, v147
    v_dot2c_f32_bf16 v207, v67, v163
    v_dot2c_f32_bf16 v203, v68, v148
    v_dot2c_f32_bf16 v207, v68, v164
    v_dot2c_f32_bf16 v203, v69, v149
    v_dot2c_f32_bf16 v207, v69, v165
    v_dot2c_f32_bf16 v203, v70, v150
    v_dot2c_f32_bf16 v207, v70, v166
    v_dot2c_f32_bf16 v203, v71, v151
    v_dot2c_f32_bf16 v207, v71, v167
    v_dot2c_f32_bf16 v203, v72, v152
    v_dot2c_f32_bf16 v207, v72, v168
    v_dot2c_f32_bf16 v203, v73, v153
    v_dot2c_f32_bf16 v207, v73, v169
    v_dot2c_f32_bf16 v203, v74, v154
    v_dot2c_f32_bf16 v207, v74, v170
    v_dot2c_f32_bf16 v203, v75, v155
    v_dot2c_f32_bf16 v207, v75, v171
    v_dot2c_f32_bf16 v203, v76, v156
    v_dot2c_f32_bf16 v207, v76, v172
    v_dot2c_f32_bf16 v203, v77, v157
    v_dot2c_f32_bf16 v207, v77, v173
    v_dot2c_f32_bf16 v203, v78, v158
    v_dot2c_f32_bf16 v207, v78, v174
    v_dot2c_f32_bf16 v203, v79, v159
    v_dot2c_f32_bf16 v207, v79, v175
    v_add_f32_dpp v200, v200, v200 row_half_mirror row_mask:0xf bank_mask:0x5
    v_add_f32_dpp v201, v201, v201 row_half_mirror row_mask:0xf bank_mask:0x5
    v_add_f32_dpp v202, v202, v202 row_half_mirror row_mask:0xf bank_mask:0x5
    v_add_f32_dpp v203, v203, v203 row_half_mirror row_mask:0xf bank_mask:0x5
    v_add_f32_dpp v200, v204, v204 row_half_mirror row_mask:0xf bank_mask:0xa
    v_add_f32_dpp v201, v205, v205 row_half_mirror row_mask:0xf bank_mask:0xa
    v_add_f32_dpp v202, v206, v206 row_half_mirror row_mask:0xf bank_mask:0xa
    v_add_f32_dpp v203, v207, v207 row_half_mirror row_mask:0xf bank_mask:0xa
    v_add_f32_dpp v200, v200, v200 quad_perm:[1,0,3,2] row_mask:0xf bank_mask:0xf
    v_add_f32_dpp v201, v201, v201 quad_perm:[1,0,3,2] row_mask:0xf bank_mask:0xf
    v_add_f32_dpp v202, v202, v202 quad_perm:[1,0,3,2] row_mask:0xf bank_mask:0xf
    v_add_f32_dpp v203, v203, v203 quad_perm:[1,0,3,2] row_mask:0xf bank_mask:0xf
    v_cndmask_b32_e64 v200, v200, v201, s[58:59]
    v_cndmask_b32_e64 v202, v202, v203, s[58:59]
    s_nop 0
    v_add_f32_dpp v200, v200, v200 quad_perm:[2,3,0,1] row_mask:0xf bank_mask:0xf
    v_add_f32_dpp v202, v202, v202 quad_perm:[2,3,0,1] row_mask:0xf bank_mask:0xf
    v_cndmask_b32_e64 v200, v200, v202, s[60:61]
    v_cvt_pk_bf16_f32 v200, 0, v200
    ds_write_b32 v13, v200 offset:1024
    ds_write_b32 v221, v220 offset:8496
    s_cmp_ge_u32 s4, 7
    s_cselect_b32 s54, 1, 0
    s_lshl1_add_u32 s7, s3, s54
    s_lshl3_add_u32 s56, s7, s5
    s_mul_i32 s56, s56, 4224
    s_add_u32 s56, s56, 0x20000
    s_cmp_eq_u32 s5, 3
    s_cbranch_scc1 L_k3
    s_cmp_ge_u32 s4, 14
    s_cbranch_scc1 L_aux6
    v_bfe_u32 v10, v1, 4, 1
    v_and_b32 v12, 7, v1
    v_lshl_add_u32 v10, v10, 3, v12
    v_mul_u32_u24 v14, 144, v10
    v_lshlrev_b32 v12, 4, v10
    v_bfe_u32 v10, v1, 3, 1
    v_lshl_add_u32 v14, v10, 6, v14
    v_lshl_add_u32 v12, v10, 13, v12
    s_and_b32 s44, s7, 3
    s_mul_i32 s44, s44, -2176
    s_lshl_b32 s7, s7, 12
    s_add_u32 s44, s44, s7
    s_mul_i32 s45, s54, 7
    s_sub_u32 s45, s4, s45
    s_lshl_b32 s45, s45, 8
    s_add_u32 s44, s44, s45
    s_add_u32 s44, s44, 0x1a0000
    s_mov_b32 s60, -1
    s_mov_b32 s61, 0
    v_mov_b32 v75, s6
L_gate2:
    ds_read_b32 v219, v221 offset:8512
    s_waitcnt lgkmcnt(0)
    v_cmp_ne_u32 vcc, 1, v219
    s_cbranch_vccnz L_gate2
    buffer_load_dwordx4 v2, s[16:19], s10 offen nt lds
    s_add_u32 m0, m0, 0x1000
    s_add_u32 s10, s10, s11
    buffer_load_dwordx4 v2, s[16:19], s10 offen nt lds
    s_add_u32 m0, m0, 0x1000
    s_add_u32 s10, s10, s11
    buffer_load_dwordx4 v2, s[16:19], s10 offen nt lds
    s_add_u32 m0, m0, 0x1000
    s_add_u32 s10, s10, s11
    buffer_load_dwordx4 v2, s[16:19], s10 offen nt lds
    s_add_u32 m0, m0, 0x1000
    s_add_u32 s10, s10, s11
    buffer_load_dwordx4 v2, s[16:19], s10 offen nt lds
    s_add_u32 m0, m0, 0x1000
    s_add_u32 s10, s10, s11
    buffer_load_dwordx4 v2, s[16:19], s10 offen nt lds
    s_add_u32 m0, m0, 0x1000
    s_add_u32 s10, s10, s11
    buffer_load_dwordx4 v2, s[16:19], s10 offen nt lds
    s_add_u32 m0, m0, 0x1000
    s_add_u32 s10, s10, s11
    buffer_load_dwordx4 v2, s[16:19], s10 offen nt lds
    s_waitcnt vmcnt(0)
    s_branch L_wt
L_k3:
    s_mov_b32 exec_hi, 0
    buffer_load_dwordx2 v[222:223], v218, s[20:23], s46 offen sc1
    s_mov_b32 exec_hi, -1
    s_lshl3_add_u32 s45, s54, s46
    s_add_u32 s57, s45, 0x8000
    s_xor_b32 s57, s57, s45
    v_lshrrev_b32 v10, 5, v1
    v_lshl_add_u32 v14, v10, 4, v8
    v_lshlrev_b32 v10, 3, v10
    s_lshl_b32 s7, s4, 7
    s_add_u32 s46, s46, s7
    v_mov_b32 v13, s6
L_gate3:
    ds_read_b32 v219, v217 offset:8496
    s_waitcnt lgkmcnt(0)
    v_cmp_ne_u32 vcc, 1, v219
    s_cbranch_vccnz L_gate3
    ds_read_b128 v[192:195], v8 offset:1024
    s_waitcnt lgkmcnt(0)
    v_max3_f32 v196, v192, v193, v194
    v_max_f32 v196, v196, v195
    s_nop 1
    v_max_f32_dpp v196, v196, v196 quad_perm:[1,0,3,2] row_mask:0xf bank_mask:0xf
    s_nop 1
    v_max_f32_dpp v196, v196, v196 quad_perm:[2,3,0,1] row_mask:0xf bank_mask:0xf
    s_nop 1
    v_max_f32_dpp v196, v196, v196 row_half_mirror row_mask:0xf bank_mask:0xf
    s_nop 1
    v_max_f32_dpp v196, v196, v196 row_mirror row_mask:0xf bank_mask:0xf
    v_mov_b32 v197, v196
    s_nop 1
    v_permlane16_swap_b32 v196, v197
    v_max_f32 v196, v196, v197
    v_mul_f32 v196, s53, v196
    v_fma_f32 v192, v192, s53, -v196
    v_fma_f32 v193, v193, s53, -v196
    v_fma_f32 v194, v194, s53, -v196
    v_fma_f32 v195, v195, s53, -v196
    v_exp_f32 v192, v192
    v_exp_f32 v193, v193
    v_exp_f32 v194, v194
    v_exp_f32 v195, v195
    v_add_f32 v198, v192, v193
    v_add_f32 v197, v194, v195
    v_add_f32 v198, v198, v197
    s_nop 1
    v_add_f32_dpp v198, v198, v198 quad_perm:[1,0,3,2] row_mask:0xf bank_mask:0xf
    s_nop 1
    v_add_f32_dpp v198, v198, v198 quad_perm:[2,3,0,1] row_mask:0xf bank_mask:0xf
    s_nop 1
    v_add_f32_dpp v198, v198, v198 row_half_mirror row_mask:0xf bank_mask:0xf
    s_nop 1
    v_add_f32_dpp v198, v198, v198 row_mirror row_mask:0xf bank_mask:0xf
    v_mov_b32 v197, v198
    s_nop 1
    v_permlane16_swap_b32 v198, v197
    v_add_f32 v198, v198, v197
    v_rcp_f32 v197, v198
    v_log_f32 v12, v198
    v_mul_f32 v192, v192, v197
    v_mul_f32 v193, v193, v197
    v_mul_f32 v194, v194, v197
    v_mul_f32 v195, v195, v197
    v_cvt_pk_bf16_f32 v192, v192, v192
    v_cvt_pk_bf16_f32 v193, v193, v193
    v_cvt_pk_bf16_f32 v194, v194, v194
    v_cvt_pk_bf16_f32 v195, v195, v195
    ds_write_b128 v14, v[192:195] offset:2048
    ds_write_b32 v221, v220 offset:8516
    v_add_f32 v12, v12, v196
    s_mov_b32 exec_lo, 1
    s_mov_b32 exec_hi, 1
    buffer_store_dwordx2 v[12:13], v10, s[20:23], s46 offen offset:16
    s_mov_b64 exec, -1
    s_waitcnt vmcnt(1)
    v_cmp_ne_u32 vcc, s6, v223
    v_cmp_ne_u32_e64 s[96:97], s44, v222
    s_or_b32 s7, vcc_lo, s96
    s_cselect_b32 s7, 2, 1
    v_mov_b32 v219, s7
    ds_write_b32 v217, v219 offset:8560
    s_lshr_b32 s47, s7, 1
    s_add_u32 s46, s46, 0x8000
    s_cmp_ge_u32 s4, 14
    s_cbranch_scc0 L_k4
    s_mov_b32 exec_lo, s47
    s_mov_b32 exec_hi, s47
    buffer_store_dwordx2 v[12:13], v10, s[20:23], s46 offen offset:16 sc1
    s_mov_b64 exec, -1
    s_branch L_aux6
L_k4:
L_gate4:
    ds_read_b32 v219, v221 offset:8512
    s_waitcnt lgkmcnt(0)
    v_cmp_ne_u32 vcc, 1, v219
    s_cbranch_vccnz L_gate4
    buffer_load_dwordx2 v[14:15], v218, s[20:23], s45 offen offset:16 sc1
    buffer_load_dwordx4 v2, s[16:19], s10 offen nt lds
    s_add_u32 m0, m0, 0x1000
    s_add_u32 s10, s10, s11
    buffer_load_dwordx4 v2, s[16:19], s10 offen nt lds
    s_add_u32 m0, m0, 0x1000
    s_add_u32 s10, s10, s11
    buffer_load_dwordx4 v2, s[16:19], s10 offen nt lds
    s_add_u32 m0, m0, 0x1000
    s_add_u32 s10, s10, s11
    buffer_load_dwordx4 v2, s[16:19], s10 offen nt lds
    s_add_u32 m0, m0, 0x1000
    s_add_u32 s10, s10, s11
    buffer_load_dwordx4 v2, s[16:19], s10 offen nt lds
    s_add_u32 m0, m0, 0x1000
    s_add_u32 s10, s10, s11
    buffer_load_dwordx4 v2, s[16:19], s10 offen nt lds
    s_add_u32 m0, m0, 0x1000
    s_add_u32 s10, s10, s11
    buffer_load_dwordx4 v2, s[16:19], s10 offen nt lds
    s_add_u32 m0, m0, 0x1000
    s_add_u32 s10, s10, s11
    buffer_load_dwordx4 v2, s[16:19], s10 offen nt lds
    s_mov_b32 exec_lo, s47
    s_mov_b32 exec_hi, s47
    buffer_store_dwordx2 v[12:13], v10, s[20:23], s46 offen offset:16 sc1
    s_mov_b64 exec, -1
    s_mov_b32 s7, 0
    s_waitcnt vmcnt(9)
L_pl_chk:
    v_cmp_ne_u32 vcc, s6, v15
    s_cbranch_vccnz L_pl_retry
L_pl_ok:
    v_mov_b32 v16, v14
    s_nop 1
    v_max_f32_dpp v16, v16, v16 quad_perm:[1,0,3,2] row_mask:0xf bank_mask:0xf
    s_nop 1
    v_max_f32_dpp v16, v16, v16 quad_perm:[2,3,0,1] row_mask:0xf bank_mask:0xf
    s_nop 1
    v_max_f32_dpp v16, v16, v16 row_half_mirror row_mask:0xf bank_mask:0xf
    s_nop 1
    v_max_f32_dpp v16, v16, v16 row_mirror row_mask:0xf bank_mask:0xf
    v_mov_b32 v17, v16
    s_nop 1
    v_permlane16_swap_b32 v16, v17
    v_max_f32 v16, v16, v17
    v_sub_f32 v14, v14, v16
    v_exp_f32 v14, v14
    v_and_b32 v10, 0x70, v8
    v_mov_b32 v16, v14
    s_nop 1
    v_add_f32_dpp v16, v16, v16 quad_perm:[1,0,3,2] row_mask:0xf bank_mask:0xf
    s_nop 1
    v_add_f32_dpp v16, v16, v16 quad_perm:[2,3,0,1] row_mask:0xf bank_mask:0xf
    s_nop 1
    v_add_f32_dpp v16, v16, v16 row_half_mirror row_mask:0xf bank_mask:0xf
    s_nop 1
    v_add_f32_dpp v16, v16, v16 row_mirror row_mask:0xf bank_mask:0xf
    v_mov_b32 v17, v16
    s_nop 1
    v_permlane16_swap_b32 v16, v17
    v_add_f32 v16, v16, v17
    v_rcp_f32 v16, v16
    v_bfe_u32 v11, v1, 3, 2
    v_lshl_add_u32 v10, v11, 2, v10
    v_mul_f32 v14, v14, v16
    ds_write_b32 v10, v14 offset:3200
    s_waitcnt vmcnt(1) lgkmcnt(0)
    s_branch L_wt
L_aux6:
    s_waitcnt lgkmcnt(0)
    s_cmp_ge_u32 s4, 16
    s_cbranch_scc0 L_aux7
    s_sub_u32 s3, s3, 1
    s_cbranch_scc1 L_fin
    s_bitcmp1_b32 s4, 0
    s_cselect_b64 s[24:25], s[28:29], s[24:25]
    v_lshrrev_b32 v12, 3, v1
    v_and_b32 v13, 0x70, v8
    v_lshl_add_u32 v13, v12, 10, v13
    v_lshl_add_u32 v13, s5, 13, v13
    v_mov_b32 v16, 0
    v_mov_b32 v17, 0
    v_mov_b32 v18, 0
    v_mov_b32 v19, 0
    ds_write_b128 v13, v[16:19] offset:15744
    s_and_b32 s7, s4, 14
    s_mul_i32 s7, s7, 7
    v_add_u32 v12, s7, v12
    v_and_b32 v10, 0x77, v12
    v_and_b32 v3, 7, v12
    v_add_u32 v10, v10, v3
    v_bfe_u32 v3, v12, 3, 1
    v_add_lshl_u32 v10, v10, v3, 2
    v_bfe_u32 v11, v1, 3, 2
    v_lshlrev_b32 v11, 1, v11
    v_xor_b32 v11, v11, v1
    v_and_b32 v11, 7, v11
    v_mul_u32_u24 v10, 3584, v10
    v_lshl_add_u32 v2, v11, 4, v10
    v_add_u32 v12, 7, v12
    v_and_b32 v10, 0x77, v12
    v_and_b32 v3, 7, v12
    v_add_u32 v10, v10, v3
    v_bfe_u32 v3, v12, 3, 1
    v_add_lshl_u32 v10, v10, v3, 2
    v_bfe_u32 v11, v1, 3, 2
    v_lshlrev_b32 v11, 1, v11
    v_xor_b32 v11, v11, v1
    v_and_b32 v11, 7, v11
    v_mul_u32_u24 v10, 3584, v10
    v_lshl_add_u32 v42, v11, 4, v10
    s_lshl2_add_u32 s57, s3, s5
    s_lshl_b32 s8, s57, 7
    s_add_u32 s9, s8, 3584
    s_add_u32 s10, s8, 7168
    s_add_u32 s11, s8, 10752
    s_lshl_b32 s7, s5, 13
    s_add_u32 m0, s7, 14848
    v_bfe_u32 v10, v1, 2, 2
    v_mul_u32_u24 v10, 160, v10
    v_and_b32 v11, 3, v1
    v_lshl_add_u32 v10, v11, 3, v10
    v_lshrrev_b32 v11, 4, v1
    v_lshl_add_u32 v10, v11, 10, v10
    v_lshl_add_u32 v32, s5, 13, v10
    v_xor_b32 v33, 32, v32
    v_xor_b32 v34, 64, v32
    v_xor_b32 v35, 96, v32
    v_lshlrev_b32 v38, 4, v11
    v_lshrrev_b32 v10, 2, v1
    v_mul_u32_u24 v10, 2112, v10
    v_add_u32 v13, v10, v8
    v_mov_b32 v112, 0x3f803f80
    v_mov_b32 v113, 0x3f803f80
    v_mov_b32 v114, 0x3f803f80
    v_mov_b32 v115, 0x3f803f80
    s_mul_i32 s57, s57, 8704
    s_lshl_b32 s7, s4, 7
    s_add_u32 s57, s57, s7
    s_add_u32 s57, s57, 0xa3800
    s_add_u32 s56, s57, 64
    v_mov_b32 v75, s6
    s_mov_b32 exec_hi, 0x00ffffff
    s_branch L_ft
L_aux7:
    s_cmp_eq_u32 s5, 3
    s_cbranch_scc1 L_aux8
    s_lshr_b32 s98, s2, 5
    s_lshl_b32 s98, s98, 3
    s_and_b32 s7, s55, 2
    s_lshl1_add_u32 s98, s7, s98
    s_and_b32 s7, s55, 1
    s_add_u32 s98, s98, s7
    s_lshl_b32 s98, s98, 5
    s_and_b32 s7, s2, 31
    s_add_u32 s98, s98, s7
    s_lshl_b32 s98, s98, 7
    s_add_u32 s98, s98, 0xc8000
    s_and_b32 s7, s55, 1
    v_xor_b32 v10, s7, v1
    v_lshlrev_b32 v10, 2, v10
    s_lshl_b32 s7, s7, 13
    s_xor_b32 s98, s98, s7
    s_xor_b32 s99, s98, 0x2000
    s_mov_b64 s[12:13], 0
    s_mov_b32 s96, 0
    s_buffer_load_dword s62, s[20:23], s98 glc
    s_buffer_load_dword s63, s[20:23], s99 glc
    s_waitcnt lgkmcnt(0)
L_probe:
    s_memtime s[14:15]
    s_buffer_load_dword s7, s[20:23], s98 glc
    s_waitcnt lgkmcnt(0)
    s_memtime s[100:101]
    s_buffer_load_dword s7, s[20:23], s99 glc
    s_waitcnt lgkmcnt(0)
    s_memtime s[62:63]
    s_sub_u32 s14, s14, s100
    s_max_u32 s12, s12, s14
    s_add_u32 s96, s96, 1
    s_waitcnt lgkmcnt(0)
    s_sub_u32 s100, s100, s62
    s_max_u32 s13, s13, s100
    s_cmp_lt_u32 s96, 2
    s_cbranch_scc1 L_probe
    v_mov_b32 v11, s12
    v_writelane_b32 v11, s13, 1
    s_mov_b64 exec, 3
    ds_max_u32 v10, v11 offset:8592
    s_mov_b64 exec, -1
L_aux8:
    ds_write_b32 v221, v220 offset:8608
    s_cmp_eq_u32 s5, 0
    s_cbranch_scc0 L_aux9
    s_lshl_b32 s7, s4, 7
    s_add_u32 s46, s46, s7
    v_mov_b32 v13, s6
L_gate5:
    ds_read_b32 v219, v217 offset:8608
    s_waitcnt lgkmcnt(0)
    v_cmp_ne_u32 vcc, 1, v219
    s_cbranch_vccnz L_gate5
    ds_read_b64 v[218:219], v221 offset:8592
    s_waitcnt lgkmcnt(0)
    v_cmp_lt_u32 vcc, v218, v219
    s_nop 1
    v_cndmask_b32_e64 v12, 0, -1, vcc
    s_mov_b64 exec, 1
    buffer_store_dwordx2 v[12:13], off, s[20:23], s46 offset:32
L_aux9:
    s_barrier
    s_endpgm
L_pq_retry:
    s_cmp_ge_u32 s7, 24
    s_cselect_b32 s62, s57, 0
    s_xor_b32 s56, s56, s62
    s_mov_b64 exec, vcc
    s_cbranch_execz L_pq_z0
    buffer_load_dwordx4 v[192:195], v8, s[20:23], s56 offen offset:0 sc1 nt
L_pq_z0:
    s_mov_b64 exec, s[96:97]
    s_cbranch_execz L_pq_z1
    buffer_load_dwordx4 v[196:199], v8, s[20:23], s56 offen offset:1024 sc1 nt
L_pq_z1:
    s_mov_b64 exec, s[98:99]
    s_cbranch_execz L_pq_z2
    buffer_load_dwordx4 v[208:211], v14, s[20:23], s56 offen sc1 nt
L_pq_z2:
    s_mov_b64 exec, -1
    s_add_u32 s7, s7, 1
    s_cmp_ge_u32 s7, 20000
    s_waitcnt vmcnt(0)
    s_cbranch_scc0 L_pq_chk
    s_branch L_pq_ok
L_pl_retry:
    s_cmp_ge_u32 s7, 40
    s_cselect_b32 s62, s57, 0
    s_xor_b32 s45, s45, s62
    s_mov_b64 exec, vcc
    buffer_load_dwordx2 v[14:15], v218, s[20:23], s45 offen offset:16 sc1
    s_mov_b64 exec, -1
    s_add_u32 s7, s7, 1
    s_cmp_ge_u32 s7, 20000
    s_waitcnt vmcnt(0)
    s_cbranch_scc0 L_pl_chk
    s_branch L_pl_ok
L_v:
    s_mov_b32 s38, 0x380
    s_mov_b32 s39, 0x20000
    s_load_dwordx2 s[24:25], s[0:1], 48
    s_load_dwordx2 s[28:29], s[0:1], 56
    s_load_dwordx2 s[32:33], s[0:1], 64
    s_load_dwordx2 s[40:41], s[0:1], 72
    s_mov_b32 s22, 0x10000000
    s_mov_b32 s23, 0x20000
    s_mov_b32 s26, 0x188000
    s_mov_b32 s27, 0x20000
    s_mov_b32 s34, 0x188000
    s_mov_b32 s35, 0x20000
    s_mov_b32 s42, 0x380
    s_mov_b32 s43, 0x20000
    s_mov_b32 s48, 0x07060501
    s_mov_b32 s49, 0x07060502
    s_mov_b32 s50, 0x07060503
    s_mov_b32 s51, 0x0c04000c
    s_mov_b32 s52, 0x04020100
    v_and_b32 v10, 1, v1
    v_lshlrev_b32 v10, 4, v10
    s_mov_b32 s7, 0xffff
    v_lshlrev_b32_e64 v10, v10, s7
    v_bfe_u32 v11, v1, 1, 2
    v_cmp_eq_u32 vcc, 0, v11
    s_nop 1
    v_cndmask_b32 v4, 0, v10, vcc
    v_cmp_eq_u32 vcc, 1, v11
    s_nop 1
    v_cndmask_b32 v5, 0, v10, vcc
    v_cmp_eq_u32 vcc, 2, v11
    s_nop 1
    v_cndmask_b32 v6, 0, v10, vcc
    v_cmp_eq_u32 vcc, 3, v11
    s_nop 1
    v_cndmask_b32 v7, 0, v10, vcc
    v_lshlrev_b32 v8, 4, v1
    v_mov_b32 v211, 0
    s_mov_b32 s100, 0x190000
    s_mov_b64 s[98:99], 0
    s_waitcnt lgkmcnt(0)
    s_mul_i32 s6, s6, 0x9e3779b1
    s_add_u32 s6, s6, 0x7f4a7c15
    s_lshl_b32 s7, s3, 5
    s_add_u32 s7, s7, s4
    s_lshl_b32 s7, s7, 7
    s_add_u32 s47, s7, 0x4000
    s_getreg_b32 s7, hwreg(HW_REG_XCC_ID, 0, 4)
    v_mov_b32 v222, s7
    v_mov_b32 v223, s6
    s_cmp_eq_u32 s5, 6
    s_cbranch_scc0 L_xp6
    s_mov_b64 exec, 1
    buffer_store_dwordx2 v[222:223], off, s[20:23], s47
    s_mov_b64 exec, -1
L_xp6:
L_v3:
    v_and_b32 v10, 7, v1
    v_lshrrev_b32 v11, 3, v1
    v_lshlrev_b32 v10, 4, v10
    v_lshl_add_u32 v2, v11, 9, v10
    s_lshl_b32 s7, s3, 7
    s_add_u32 s7, s7, s4
    s_add_u32 s7, s7, 96
    s_lshl_b32 s44, s7, 4
    s_and_b32 s7, s4, 15
    s_or_b32 s44, s44, s7
    s_mov_b32 s14, 0x4000000
    s_mov_b32 s15, 0x20000
    s_lshl_b32 s44, s44, 12
    s_lshl_b32 s7, s55, 7
    s_add_u32 s44, s44, s7
    v_lshlrev_b32_e64 v221, 2, s55
    v_mov_b32 v220, 1
    v_and_b32 v10, 3, v1
    v_lshlrev_b32 v217, 2, v10
    v_bfe_u32 v11, v1, 3, 1
    v_lshrrev_b32 v12, 4, v1
    v_mul_u32_u24 v15, 528, v11
    v_lshl_add_u32 v15, v12, 7, v15
    v_lshrrev_b32 v10, 5, v1
    v_bfe_u32 v11, v1, 2, 1
    v_lshl_add_u32 v10, v10, 3, v11
    v_mul_u32_u24 v10, 4224, v10
    v_and_b32 v11, 3, v1
    v_lshl_add_u32 v10, v11, 4, v10
    v_bfe_u32 v11, v1, 4, 1
    v_lshl_add_u32 v9, v11, 6, v10
    s_lshl3_add_u32 s7, s3, s55
    s_mul_i32 s57, s7, 8448
    s_lshl_b32 s7, s4, 7
    s_add_u32 s57, s57, s7
    s_add_u32 s57, s57, 0x20000
    v_not_b32 v75, s6
    s_mov_b32 exec_lo, 0x00ff00ff
    s_mov_b32 exec_hi, 0x00ff00ff
    buffer_load_dwordx4 v[16:19], v9, s[20:23], s57 offen nt
    buffer_store_dwordx4 v[72:75], v9, s[20:23], s57 offen
    s_mov_b64 exec, -1
    s_cmp_ge_u32 s4, 7
    s_cselect_b32 s54, 1, 0
    s_lshl1_add_u32 s7, s3, s54
    s_lshl3_add_u32 s56, s7, s5
    s_mul_i32 s56, s56, 4224
    s_add_u32 s56, s56, 0x20000
    v_mov_b32 v64, 0
    v_mov_b32 v65, 0
    v_mov_b32 v66, 0
    v_mov_b32 v67, 0
    v_mov_b32 v68, 0
    v_mov_b32 v69, 0
    v_mov_b32 v70, 0
    v_mov_b32 v71, 0
    v_mov_b32 v75, s6
L_gate7:
    ds_read_b32 v219, v217 offset:8448
    s_waitcnt lgkmcnt(0)
    v_cmp_ne_u32 vcc, 1, v219
    s_cbranch_vccnz L_gate7
    buffer_load_dwordx4 v[80:83], v2, s[12:15], s44 offen nt
    s_xor_b32 s44, s44, 0x1000
    buffer_load_dwordx4 v[84:87], v2, s[12:15], s44 offen nt
    s_xor_b32 s44, s44, 0x3000
    buffer_load_dwordx4 v[88:91], v2, s[12:15], s44 offen nt
    s_xor_b32 s44, s44, 0x1000
    buffer_load_dwordx4 v[92:95], v2, s[12:15], s44 offen nt
    s_xor_b32 s44, s44, 0x7000
    buffer_load_dwordx4 v[96:99], v2, s[12:15], s44 offen nt
    s_xor_b32 s44, s44, 0x1000
    buffer_load_dwordx4 v[100:103], v2, s[12:15], s44 offen nt
    s_waitcnt vmcnt(5)
    s_xor_b32 s44, s44, 0x3000
    buffer_load_dwordx4 v[104:107], v2, s[12:15], s44 offen nt
    s_waitcnt vmcnt(5)
    s_xor_b32 s44, s44, 0x1000
    buffer_load_dwordx4 v[108:111], v2, s[12:15], s44 offen nt
    s_waitcnt vmcnt(5)
    s_xor_b32 s44, s44, 0xf000
    buffer_load_dwordx4 v[112:115], v2, s[12:15], s44 offen nt
    s_waitcnt vmcnt(5)
    s_xor_b32 s44, s44, 0x1000
    buffer_load_dwordx4 v[116:119], v2, s[12:15], s44 offen nt
    s_waitcnt vmcnt(5)
    s_xor_b32 s44, s44, 0x3000
    buffer_load_dwordx4 v[120:123], v2, s[12:15], s44 offen nt
    s_waitcnt vmcnt(5)
    s_xor_b32 s44, s44, 0x1000
    buffer_load_dwordx4 v[124:127], v2, s[12:15], s44 offen nt
    s_waitcnt vmcnt(5)
    s_xor_b32 s44, s44, 0x7000
    buffer_load_dwordx4 v[128:131], v2, s[12:15], s44 offen nt
    s_waitcnt vmcnt(5)
    s_xor_b32 s44, s44, 0x1000
    buffer_load_dwordx4 v[132:135], v2, s[12:15], s44 offen nt
    s_waitcnt vmcnt(5)
    s_xor_b32 s44, s44, 0x3000
    buffer_load_dwordx4 v[136:139], v2, s[12:15], s44 offen nt
    s_waitcnt vmcnt(5)
    s_xor_b32 s44, s44, 0x1000
    buffer_load_dwordx4 v[140:143], v2, s[12:15], s44 offen nt
    ds_write_b32 v221, v220 offset:8512
    v_mov_b32 v219, 0
    s_mov_b32 s7, 0
L_g5:
    ds_read_b32 v219, v219 offset:8528
    s_add_u32 s7, s7, 1
    s_cmp_eq_u32 s7, 64
    s_cbranch_scc1 L_qb5
L_qb5_ret:
    s_waitcnt lgkmcnt(0)
    v_cmp_ne_u32 vcc, 1, v219
    s_cbranch_vccnz L_g5
    ds_read_b128 v[16:19], v15 offset:2048
    ds_read_b128 v[20:23], v15 offset:2064
    ds_read_b128 v[24:27], v15 offset:2080
    ds_read_b128 v[28:31], v15 offset:2096
    ds_read_b128 v[32:35], v15 offset:2112
    ds_read_b128 v[36:39], v15 offset:2128
    ds_read_b128 v[40:43], v15 offset:2144
    ds_read_b128 v[44:47], v15 offset:2160
    s_waitcnt lgkmcnt(0)
    v_and_b32 v48, v16, v4
    v_and_b32 v49, v16, v5
    v_and_b32 v50, v16, v6
    v_and_b32 v51, v16, v7
    v_and_b32 v52, v17, v4
    v_and_b32 v53, v17, v5
    v_and_b32 v54, v17, v6
    v_and_b32 v55, v17, v7
    v_mfma_f32_16x16x32_bf16 v[64:67], v[48:51], v[80:83], v[64:67]
    v_and_b32 v56, v18, v4
    v_and_b32 v57, v18, v5
    v_and_b32 v58, v18, v6
    v_and_b32 v59, v18, v7
    v_mfma_f32_16x16x32_bf16 v[68:71], v[52:55], v[80:83], v[68:71]
    v_and_b32 v60, v19, v4
    v_and_b32 v61, v19, v5
    v_and_b32 v62, v19, v6
    v_and_b32 v63, v19, v7
    v_mfma_f32_16x16x32_bf16 v[64:67], v[56:59], v[84:87], v[64:67]
    v_and_b32 v48, v20, v4
    v_and_b32 v49, v20, v5
    v_and_b32 v50, v20, v6
    v_and_b32 v51, v20, v7
    v_mfma_f32_16x16x32_bf16 v[68:71], v[60:63], v[84:87], v[68:71]
    v_and_b32 v52, v21, v4
    v_and_b32 v53, v21, v5
    v_and_b32 v54, v21, v6
    v_and_b32 v55, v21, v7
    v_mfma_f32_16x16x32_bf16 v[64:67], v[48:51], v[88:91], v[64:67]
    v_and_b32 v56, v22, v4
    v_and_b32 v57, v22, v5
    v_and_b32 v58, v22, v6
    v_and_b32 v59, v22, v7
    v_mfma_f32_16x16x32_bf16 v[68:71], v[52:55], v[88:91], v[68:71]
    v_and_b32 v60, v23, v4
    v_and_b32 v61, v23, v5
    v_and_b32 v62, v23, v6
    v_and_b32 v63, v23, v7
    v_mfma_f32_16x16x32_bf16 v[64:67], v[56:59], v[92:95], v[64:67]
    v_and_b32 v48, v24, v4
    v_and_b32 v49, v24, v5
    v_and_b32 v50, v24, v6
    v_and_b32 v51, v24, v7
    v_mfma_f32_16x16x32_bf16 v[68:71], v[60:63], v[92:95], v[68:71]
    v_and_b32 v52, v25, v4
    v_and_b32 v53, v25, v5
    v_and_b32 v54, v25, v6
    v_and_b32 v55, v25, v7
    v_mfma_f32_16x16x32_bf16 v[64:67], v[48:51], v[96:99], v[64:67]
    v_and_b32 v56, v26, v4
    v_and_b32 v57, v26, v5
    v_and_b32 v58, v26, v6
    v_and_b32 v59, v26, v7
    v_mfma_f32_16x16x32_bf16 v[68:71], v[52:55], v[96:99], v[68:71]
    v_and_b32 v60, v27, v4
    v_and_b32 v61, v27, v5
    v_and_b32 v62, v27, v6
    v_and_b32 v63, v27, v7
    v_mfma_f32_16x16x32_bf16 v[64:67], v[56:59], v[100:103], v[64:67]
    v_and_b32 v48, v28, v4
    v_and_b32 v49, v28, v5
    v_and_b32 v50, v28, v6
    v_and_b32 v51, v28, v7
    v_mfma_f32_16x16x32_bf16 v[68:71], v[60:63], v[100:103], v[68:71]
    v_and_b32 v52, v29, v4
    v_and_b32 v53, v29, v5
    v_and_b32 v54, v29, v6
    v_and_b32 v55, v29, v7
    v_mfma_f32_16x16x32_bf16 v[64:67], v[48:51], v[104:107], v[64:67]
    v_and_b32 v56, v30, v4
    v_and_b32 v57, v30, v5
    v_and_b32 v58, v30, v6
    v_and_b32 v59, v30, v7
    v_mfma_f32_16x16x32_bf16 v[68:71], v[52:55], v[104:107], v[68:71]
    v_and_b32 v60, v31, v4
    v_and_b32 v61, v31, v5
    v_and_b32 v62, v31, v6
    v_and_b32 v63, v31, v7
    v_mfma_f32_16x16x32_bf16 v[64:67], v[56:59], v[108:111], v[64:67]
    v_and_b32 v48, v32, v4
    v_and_b32 v49, v32, v5
    v_and_b32 v50, v32, v6
    v_and_b32 v51, v32, v7
    v_mfma_f32_16x16x32_bf16 v[68:71], v[60:63], v[108:111], v[68:71]
    v_and_b32 v52, v33, v4
    v_and_b32 v53, v33, v5
    v_and_b32 v54, v33, v6
    v_and_b32 v55, v33, v7
    v_mfma_f32_16x16x32_bf16 v[64:67], v[48:51], v[112:115], v[64:67]
    v_and_b32 v56, v34, v4
    v_and_b32 v57, v34, v5
    v_and_b32 v58, v34, v6
    v_and_b32 v59, v34, v7
    v_mfma_f32_16x16x32_bf16 v[68:71], v[52:55], v[112:115], v[68:71]
    v_and_b32 v60, v35, v4
    v_and_b32 v61, v35, v5
    v_and_b32 v62, v35, v6
    v_and_b32 v63, v35, v7
    v_mfma_f32_16x16x32_bf16 v[64:67], v[56:59], v[116:119], v[64:67]
    v_and_b32 v48, v36, v4
    v_and_b32 v49, v36, v5
    v_and_b32 v50, v36, v6
    v_and_b32 v51, v36, v7
    v_mfma_f32_16x16x32_bf16 v[68:71], v[60:63], v[116:119], v[68:71]
    v_and_b32 v52, v37, v4
    v_and_b32 v53, v37, v5
    v_and_b32 v54, v37, v6
    v_and_b32 v55, v37, v7
    s_waitcnt vmcnt(5)
    v_mfma_f32_16x16x32_bf16 v[64:67], v[48:51], v[120:123], v[64:67]
    v_and_b32 v56, v38, v4
    v_and_b32 v57, v38, v5
    v_and_b32 v58, v38, v6
    v_and_b32 v59, v38, v7
    v_mfma_f32_16x16x32_bf16 v[68:71], v[52:55], v[120:123], v[68:71]
    v_and_b32 v60, v39, v4
    v_and_b32 v61, v39, v5
    v_and_b32 v62, v39, v6
    v_and_b32 v63, v39, v7
    s_waitcnt vmcnt(4)
    v_mfma_f32_16x16x32_bf16 v[64:67], v[56:59], v[124:127], v[64:67]
    v_and_b32 v48, v40, v4
    v_and_b32 v49, v40, v5
    v_and_b32 v50, v40, v6
    v_and_b32 v51, v40, v7
    v_mfma_f32_16x16x32_bf16 v[68:71], v[60:63], v[124:127], v[68:71]
    v_and_b32 v52, v41, v4
    v_and_b32 v53, v41, v5
    v_and_b32 v54, v41, v6
    v_and_b32 v55, v41, v7
    s_waitcnt vmcnt(3)
    v_mfma_f32_16x16x32_bf16 v[64:67], v[48:51], v[128:131], v[64:67]
    v_and_b32 v56, v42, v4
    v_and_b32 v57, v42, v5
    v_and_b32 v58, v42, v6
    v_and_b32 v59, v42, v7
    v_mfma_f32_16x16x32_bf16 v[68:71], v[52:55], v[128:131], v[68:71]
    v_and_b32 v60, v43, v4
    v_and_b32 v61, v43, v5
    v_and_b32 v62, v43, v6
    v_and_b32 v63, v43, v7
    ds_read_b32 v219, v217 offset:8560
    s_waitcnt vmcnt(2)
    v_mfma_f32_16x16x32_bf16 v[64:67], v[56:59], v[132:135], v[64:67]
    v_and_b32 v48, v44, v4
    v_and_b32 v49, v44, v5
    v_and_b32 v50, v44, v6
    v_and_b32 v51, v44, v7
    v_mfma_f32_16x16x32_bf16 v[68:71], v[60:63], v[132:135], v[68:71]
    v_and_b32 v52, v45, v4
    v_and_b32 v53, v45, v5
    v_and_b32 v54, v45, v6
    v_and_b32 v55, v45, v7
    s_waitcnt vmcnt(1)
    v_mfma_f32_16x16x32_bf16 v[64:67], v[48:51], v[136:139], v[64:67]
    v_and_b32 v56, v46, v4
    v_and_b32 v57, v46, v5
    v_and_b32 v58, v46, v6
    v_and_b32 v59, v46, v7
    v_mfma_f32_16x16x32_bf16 v[68:71], v[52:55], v[136:139], v[68:71]
    v_and_b32 v60, v47, v4
    v_and_b32 v61, v47, v5
    v_and_b32 v62, v47, v6
    v_and_b32 v63, v47, v7
    s_waitcnt lgkmcnt(0)
L_xf_chk:
    v_cmp_eq_u32 vcc, 0, v219
    s_cbranch_vccnz L_xf_retry
    v_cmp_ne_u32 vcc, 1, v219
    s_cmp_eq_u64 vcc, 0
    s_cselect_b32 s47, -1, 0
    s_cbranch_scc0 L_qb7
L_qb7_ret:
    s_and_b32 s58, s47, 0x00ff00ff
    s_mov_b32 s59, s58
    s_andn2_b32 s60, 0x00ff00ff, s47
    s_mov_b32 s61, s60
    s_waitcnt vmcnt(0)
    v_mfma_f32_16x16x32_bf16 v[64:67], v[56:59], v[140:143], v[64:67]
    v_mfma_f32_16x16x32_bf16 v[68:71], v[60:63], v[140:143], v[68:71]
    s_nop 7
    v_add_f32_dpp v67, v71, v67 row_ror:8 row_mask:0xf bank_mask:0xf
    v_add_f32_dpp v64, v68, v64 row_ror:8 row_mask:0xf bank_mask:0xf
    v_add_f32_dpp v65, v69, v65 row_ror:8 row_mask:0xf bank_mask:0xf
    v_add_f32_dpp v66, v70, v66 row_ror:8 row_mask:0xf bank_mask:0xf
    v_perm_b32 v72, v64, v67, s48
    v_perm_b32 v73, v65, v67, s49
    v_perm_b32 v74, v66, v67, s50
    s_mov_b64 exec, s[58:59]
    buffer_store_dwordx4 v[72:75], v9, s[20:23], s57 offen
    s_mov_b64 exec, s[60:61]
    buffer_store_dwordx4 v[72:75], v9, s[20:23], s57 offen sc1
    s_mov_b64 exec, -1
    s_cmp_ge_u32 s4, 14
    s_cbranch_scc1 L_ft0
L_wt:
    s_barrier
    buffer_load_dwordx4 v[16:19], v8, s[20:23], s56 offen offset:0 sc1
    buffer_load_dwordx4 v[20:23], v8, s[20:23], s56 offen offset:1024 sc1
    buffer_load_dwordx4 v[24:27], v8, s[20:23], s56 offen offset:2048 sc1
    buffer_load_dwordx4 v[28:31], v8, s[20:23], s56 offen offset:3072 sc1
    v_lshrrev_b32 v10, 3, v1
    v_lshlrev_b32 v15, 4, v10
    v_bfe_u32 v10, v1, 2, 2
    v_mul_u32_u24 v10, 160, v10
    v_and_b32 v11, 3, v1
    v_lshl_add_u32 v10, v11, 3, v10
    v_lshrrev_b32 v11, 4, v1
    v_lshl_add_u32 v10, v11, 10, v10
    v_lshl_add_u32 v32, s5, 12, v10
    v_xor_b32 v33, 32, v32
    v_xor_b32 v34, 64, v32
    v_xor_b32 v35, 96, v32
    ds_read_b128 v[36:39], v15 offset:3200
    ds_read_b64_tr_b16 v[80:81], v32 offset:14848
    ds_read_b64_tr_b16 v[82:83], v32 offset:15360
    ds_read_b64_tr_b16 v[84:85], v33 offset:14848
    ds_read_b64_tr_b16 v[86:87], v33 offset:15360
    ds_read_b64_tr_b16 v[88:89], v34 offset:14848
    ds_read_b64_tr_b16 v[90:91], v34 offset:15360
    ds_read_b64_tr_b16 v[92:93], v35 offset:14848
    ds_read_b64_tr_b16 v[94:95], v35 offset:15360
    v_bfe_u32 v10, v1, 4, 1
    v_lshrrev_b32 v11, 5, v1
    v_lshl_add_u32 v13, v10, 3, v11
    v_mul_u32_u24 v13, 144, v13
    v_lshl_add_u32 v13, s5, 4, v13
    s_mov_b32 s58, 0x00010001
    s_mov_b32 s59, 0x00010001
    s_mov_b32 s7, 0
    s_waitcnt vmcnt(0) lgkmcnt(0)
L_p0_chk:
    v_cmp_ne_u32 vcc, s6, v19
    v_cmp_ne_u32_e64 s[96:97], s6, v23
    v_cmp_ne_u32_e64 s[98:99], s6, v27
    v_cmp_ne_u32_e64 s[100:101], s6, v31
    s_or_b64 s[62:63], vcc, s[96:97]
    s_or_b64 s[62:63], s[62:63], s[98:99]
    s_or_b64 s[62:63], s[62:63], s[100:101]
    s_cbranch_scc1 L_p0_retry
L_p0_ok:
    v_perm_b32 v19, v17, v16, s51
    v_perm_b32 v23, v21, v20, s51
    v_perm_b32 v27, v25, v24, s51
    v_perm_b32 v31, v29, v28, s51
    v_perm_b32 v19, v18, v19, s52
    v_perm_b32 v23, v22, v23, s52
    v_perm_b32 v27, v26, v27, s52
    v_perm_b32 v31, v30, v31, s52
    v_pk_mul_f32 v[16:17], v[16:17], v[36:37] op_sel:[0,0] op_sel_hi:[1,0]
    v_pk_mul_f32 v[18:19], v[18:19], v[36:37] op_sel:[0,0] op_sel_hi:[1,0]
    v_pk_fma_f32 v[16:17], v[20:21], v[36:37], v[16:17] op_sel:[0,1,0] op_sel_hi:[1,1,1]
    v_pk_fma_f32 v[18:19], v[22:23], v[36:37], v[18:19] op_sel:[0,1,0] op_sel_hi:[1,1,1]
    v_pk_fma_f32 v[16:17], v[24:25], v[38:39], v[16:17] op_sel:[0,0,0] op_sel_hi:[1,0,1]
    v_pk_fma_f32 v[18:19], v[26:27], v[38:39], v[18:19] op_sel:[0,0,0] op_sel_hi:[1,0,1]
    v_pk_fma_f32 v[16:17], v[28:29], v[38:39], v[16:17] op_sel:[0,1,0] op_sel_hi:[1,1,1]
    v_pk_fma_f32 v[18:19], v[30:31], v[38:39], v[18:19] op_sel:[0,1,0] op_sel_hi:[1,1,1]
    s_nop 1
    v_permlane32_swap_b32 v16, v18
    v_permlane32_swap_b32 v17, v19
    v_pk_add_f32 v[16:17], v[16:17], v[18:19]
    s_nop 1
    v_permlane16_swap_b32 v16, v17
    v_add_f32 v16, v16, v17
    s_nop 1
    v_add_f32_dpp v16, v16, v16 row_ror:8 row_mask:0xf bank_mask:0xf
    v_cvt_pk_bf16_f32 v17, 0, v16
    v_cvt_pk_bf16_f32 v16, v16, 0
    s_nop 1
    v_or_b32_dpp v16, v17, v16 quad_perm:[1,1,3,3] row_mask:0xf bank_mask:0xf
    s_nop 1
    v_mov_b32_dpp v96, v16 row_newbcast:0 row_mask:0xf bank_mask:0xf
    v_mov_b32_dpp v97, v16 row_newbcast:2 row_mask:0xf bank_mask:0xf
    v_mov_b32_dpp v98, v16 row_newbcast:4 row_mask:0xf bank_mask:0xf
    v_mov_b32_dpp v99, v16 row_newbcast:6 row_mask:0xf bank_mask:0xf
    s_nop 1
    v_mfma_f32_16x16x32_bf16 v[100:103], v[80:83], v[96:99], 0
    v_mfma_f32_16x16x32_bf16 v[104:107], v[84:87], v[96:99], 0
    v_mfma_f32_16x16x32_bf16 v[108:111], v[88:91], v[96:99], 0
    v_mfma_f32_16x16x32_bf16 v[112:115], v[92:95], v[96:99], 0
    s_mov_b64 exec, s[58:59]
    s_nop 3
    ds_write_b128 v13, v[100:103] offset:9728
    ds_write_b128 v13, v[104:107] offset:10016
    ds_write_b128 v13, v[108:111] offset:10304
    ds_write_b128 v13, v[112:115] offset:10592
    s_cmp_eq_u32 s5, 0
    s_cselect_b64 exec, s[60:61], -1
    s_waitcnt lgkmcnt(0)
    s_barrier
    s_cbranch_scc0 L_d0
    ds_read_b128 v[16:19], v14 offset:9728
    ds_read_b128 v[20:23], v14 offset:9744
    ds_read_b128 v[24:27], v14 offset:9760
    ds_read_b128 v[28:31], v14 offset:9776
    s_waitcnt lgkmcnt(2)
    v_pk_add_f32 v[16:17], v[16:17], v[20:21]
    v_pk_add_f32 v[18:19], v[18:19], v[22:23]
    s_waitcnt lgkmcnt(0)
    v_pk_add_f32 v[26:27], v[26:27], v[30:31]
    v_pk_add_f32 v[24:25], v[24:25], v[28:29]
    v_pk_add_f32 v[18:19], v[18:19], v[26:27]
    v_pk_add_f32 v[16:17], v[16:17], v[24:25]
    s_nop 0
    v_add_f32_dpp v19, v19, v19 row_ror:8 row_mask:0xf bank_mask:0xf
    v_add_f32_dpp v18, v18, v18 row_ror:8 row_mask:0xf bank_mask:0xf
    v_add_f32_dpp v16, v16, v16 row_ror:8 row_mask:0xf bank_mask:0xf
    v_add_f32_dpp v17, v17, v17 row_ror:8 row_mask:0xf bank_mask:0xf
    v_perm_b32 v72, v16, v19, s48
    v_perm_b32 v73, v17, v19, s49
    v_perm_b32 v74, v18, v19, s50
    buffer_store_dwordx4 v[72:75], v12, s[20:23], s44 offen sc1
    s_barrier
    s_endpgm
L_p0_retry:
    s_mov_b64 exec, vcc
    s_cbranch_execz L_p0_z0
    buffer_load_dwordx4 v[16:19], v8, s[20:23], s56 offen offset:0 sc1
L_p0_z0:
    s_mov_b64 exec, s[96:97]
    s_cbranch_execz L_p0_z1
    buffer_load_dwordx4 v[20:23], v8, s[20:23], s56 offen offset:1024 sc1
L_p0_z1:
    s_mov_b64 exec, s[98:99]
    s_cbranch_execz L_p0_z2
    buffer_load_dwordx4 v[24:27], v8, s[20:23], s56 offen offset:2048 sc1
L_p0_z2:
    s_mov_b64 exec, s[100:101]
    s_cbranch_execz L_p0_z3
    buffer_load_dwordx4 v[28:31], v8, s[20:23], s56 offen offset:3072 sc1
L_p0_z3:
    s_mov_b64 exec, -1
    s_add_u32 s7, s7, 1
    s_cmp_ge_u32 s7, 20000
    s_waitcnt vmcnt(0)
    s_cbranch_scc0 L_p0_chk
    s_branch L_p0_ok
L_qb5:
    s_cmp_eq_u32 s31, 0
    s_cbranch_scc1 L_qb5_ret
    s_mov_b64 exec, s[98:99]
    buffer_store_dwordx4 v[212:215], v211, s[20:23], s100 offen sc1
    s_mov_b64 exec, -1
    s_branch L_qb5_ret
L_qb7:
    s_cmp_eq_u32 s31, 0
    s_cbranch_scc1 L_qb7_ret
    s_mov_b64 exec, s[98:99]
    buffer_store_dwordx4 v[212:215], v211, s[20:23], s100 offen sc1
    s_mov_b64 exec, -1
    s_branch L_qb7_ret
L_xf_retry:
    ds_read_b32 v219, v217 offset:8560
    s_waitcnt lgkmcnt(0)
    s_branch L_xf_chk
L_ft0:
    s_cmp_ge_u32 s4, 16
    s_cbranch_scc0 L_d1
    s_sub_u32 s3, s3, 1
    s_cbranch_scc0 L_fkv
L_fin:
    s_cmp_ge_u32 s4, 30
    s_cbranch_scc0 L_stay8
    s_endpgm
L_stay8:
    s_sub_u32 s4, s4, 16
L_fin0:
    s_barrier
    v_bfe_u32 v10, v1, 3, 2
    v_mul_u32_u24 v10, 1920, v10
    v_lshrrev_b32 v11, 5, v1
    v_lshl_add_u32 v10, v11, 14, v10
    v_and_b32 v11, 0x70, v8
    v_add_u32 v9, v10, v11
    v_lshrrev_b32 v10, 4, v1
    v_lshl_add_u32 v12, v10, 1, v11
    v_and_b32 v13, 7, v1
    v_lshl_add_u32 v14, v10, 3, v13
    s_mov_b32 s54, s4
    v_mul_u32_u24 v14, 48, v14
    v_lshl_add_u32 v10, s5, 2, v14
    s_lshl_b32 s44, s54, 7
    s_add_u32 s44, s44, 0x1a0000
    s_lshr_b32 s46, s54, 1
    s_lshl_b32 s46, s46, 7
    s_and_b32 s7, s54, 1
    s_lshl3_add_u32 s46, s7, s46
    s_and_b32 s63, s2, 0
    s_lshl_b32 s63, s63, 16
    s_lshl_b32 s7, s5, 16
    s_sub_u32 s7, s7, 0x90000
    s_cmp_eq_u32 s5, 7
    s_cselect_b32 s7, s63, s7
    s_add_u32 s44, s44, s7
    s_cmp_eq_u32 s5, 7
    s_cbranch_scc1 L_fin7
    v_mov_b32 v11, 0
    s_barrier
    ds_read_b32 v11, v11 offset:8704
    s_add_u32 s45, s44, 0x8000
    s_waitcnt lgkmcnt(0)
    v_add_u32 v9, v9, v11
    buffer_load_dwordx4 v[16:19], v9, s[20:23], s44 offen sc1
    buffer_load_dwordx4 v[20:23], v9, s[20:23], s45 offen sc1
    s_mov_b32 s7, 0
    s_mov_b64 vcc, -1
    s_mov_b64 s[96:97], -1
L_p2_loop:
    s_or_b64 exec, vcc, 1
    buffer_load_dwordx4 v[24:27], v9, s[20:23], s44 offen sc1
    s_or_b64 exec, s[96:97], 1
    buffer_load_dwordx4 v[28:31], v9, s[20:23], s45 offen sc1
    s_mov_b64 exec, -1
    s_waitcnt vmcnt(2)
    v_cmp_ne_u32 vcc, s6, v19
    v_cmp_ne_u32_e64 s[96:97], s6, v23
    s_or_b64 s[62:63], vcc, s[96:97]
    s_cbranch_scc0 L_p2_ok0
    s_or_b64 exec, vcc, 1
    buffer_load_dwordx4 v[16:19], v9, s[20:23], s44 offen sc1
    s_or_b64 exec, s[96:97], 1
    buffer_load_dwordx4 v[20:23], v9, s[20:23], s45 offen sc1
    s_mov_b64 exec, -1
    s_waitcnt vmcnt(2)
    v_cmp_ne_u32 vcc, s6, v27
    v_cmp_ne_u32_e64 s[96:97], s6, v31
    s_or_b64 s[62:63], vcc, s[96:97]
    s_cbranch_scc0 L_p2_ok1
    s_add_u32 s7, s7, 1
    s_cmp_ge_u32 s7, 20000
    s_cbranch_scc0 L_p2_loop
L_p2_ok1:
    v_perm_b32 v27, v25, v24, s51
    v_perm_b32 v31, v29, v28, s51
    v_perm_b32 v27, v26, v27, s52
    v_perm_b32 v31, v30, v31, s52
    v_pk_add_f32 v[24:25], v[24:25], v[28:29]
    v_pk_add_f32 v[26:27], v[26:27], v[30:31]
    s_nop 1
    v_permlane32_swap_b32 v24, v26
    v_permlane32_swap_b32 v25, v27
    v_pk_add_f32 v[24:25], v[24:25], v[26:27]
    s_nop 1
    v_permlane16_swap_b32 v24, v25
    v_add_f32 v24, v24, v25
    s_nop 1
    v_add_f32_dpp v24, v24, v24 row_ror:8 row_mask:0xf bank_mask:0xf
    ds_write_b32 v10, v24 offset:9728
    s_waitcnt lgkmcnt(0)
    s_barrier
    s_endpgm
L_p2_ok0:
    v_perm_b32 v19, v17, v16, s51
    v_perm_b32 v23, v21, v20, s51
    v_perm_b32 v19, v18, v19, s52
    v_perm_b32 v23, v22, v23, s52
    v_pk_add_f32 v[16:17], v[16:17], v[20:21]
    v_pk_add_f32 v[18:19], v[18:19], v[22:23]
    s_nop 1
    v_permlane32_swap_b32 v16, v18
    v_permlane32_swap_b32 v17, v19
    v_pk_add_f32 v[16:17], v[16:17], v[18:19]
    s_nop 1
    v_permlane16_swap_b32 v16, v17
    v_add_f32 v16, v16, v17
    s_nop 1
    v_add_f32_dpp v16, v16, v16 row_ror:8 row_mask:0xf bank_mask:0xf
    ds_write_b32 v10, v16 offset:9728
    s_waitcnt lgkmcnt(0)
    s_barrier
    s_endpgm
L_sf_retry:
    s_add_u32 s62, s62, 1
    s_cmp_ge_u32 s62, 12
    s_cbranch_scc1 L_sf_ok
    s_mov_b64 exec, 3
    buffer_load_dwordx2 v[218:219], v217, s[20:23], s45 offen offset:1824 sc1
    s_mov_b64 exec, -1
    s_branch L_sf_wait
L_fin7:
    v_mov_b32 v11, 0
    ds_write_b32 v10, v11 offset:9728
    v_lshlrev_b32 v217, 7, v1
    s_lshl_b32 s45, s3, 12
    s_add_u32 s45, s45, 0x5000
    s_mov_b32 s62, 0
    s_mov_b64 exec, 3
    buffer_load_dwordx2 v[218:219], v217, s[20:23], s45 offen offset:1824 sc1
    s_mov_b64 exec, -1
L_sf_wait:
    s_waitcnt vmcnt(0)
    v_cmp_eq_u32 vcc, s6, v219
    s_and_b32 s7, vcc_lo, 3
    s_cbranch_scc0 L_sf_retry
    s_ff1_i32_b32 s7, s7
    v_readlane_b32 s7, v218, s7
    s_and_b32 s7, s7, 0x2000
    s_add_u32 s44, s44, s7
L_sf_ok:
    s_add_u32 s45, s44, 0x8000
    s_and_b32 s7, s44, 0x2000
    v_mov_b32 v13, s7
    ds_write_b32 v11, v13 offset:8704
    v_bfe_u32 v11, v1, 3, 1
    v_lshl_add_u32 v14, v11, 4, v14
    s_mov_b32 s58, 0xff00ff
    s_mov_b32 s59, s58
    buffer_load_ushort v15, v12, s[36:39], s46 offen
    buffer_load_ushort v216, v12, s[40:43], s46 offen
    buffer_load_dwordx4 v[16:19], v9, s[20:23], s44 offen sc1
    buffer_load_dwordx4 v[20:23], v9, s[20:23], s45 offen sc1
    s_mov_b32 s7, 0
    s_waitcnt vmcnt(0) lgkmcnt(0)
L_p3_chk:
    v_cmp_ne_u32 vcc, s6, v19
    v_cmp_ne_u32_e64 s[96:97], s6, v23
    s_or_b64 s[62:63], vcc, s[96:97]
    s_cbranch_scc1 L_p3_retry
L_p3_ok:
    s_barrier
    v_mov_b32 v10, s6
    s_cmp_eq_u32 s4, 0
    s_cselect_b64 exec, 1, 0
    buffer_store_dword v10, off, s[20:23], 0
    s_mov_b64 exec, -1
    v_perm_b32 v19, v17, v16, s51
    v_perm_b32 v23, v21, v20, s51
    v_perm_b32 v19, v18, v19, s52
    v_perm_b32 v23, v22, v23, s52
    v_pk_add_f32 v[16:17], v[16:17], v[20:21]
    v_pk_add_f32 v[18:19], v[18:19], v[22:23]
    s_nop 1
    v_permlane32_swap_b32 v16, v18
    v_permlane32_swap_b32 v17, v19
    v_pk_add_f32 v[16:17], v[16:17], v[18:19]
    s_nop 1
    v_permlane16_swap_b32 v16, v17
    v_add_f32 v16, v16, v17
    s_nop 1
    v_add_f32_dpp v16, v16, v16 row_ror:8 row_mask:0xf bank_mask:0xf
    v_lshlrev_b32 v15, 16, v15
    v_cvt_pk_bf16_f32 v16, 0, v16
    v_add_f32 v15, v16, v15
    v_cvt_pk_bf16_f32 v15, 0, v15
    s_waitcnt lgkmcnt(0)
    s_barrier
    ds_read_b128 v[16:19], v14 offset:9728
    s_waitcnt lgkmcnt(0)
    v_pk_add_f32 v[16:17], v[16:17], v[18:19]
    v_add_f32 v16, v16, v17
    s_nop 1
    v_add_f32_dpp v16, v16, v16 row_ror:8 row_mask:0xf bank_mask:0xf
    v_cvt_pk_bf16_f32 v16, 0, v16
    v_add_f32 v16, v16, v15
    v_cvt_pk_bf16_f32 v16, v16, v16
    s_mov_b64 exec, s[58:59]
    buffer_store_short v16, v12, s[40:43], s46 offen
    s_endpgm
L_p3_retry:
    s_mov_b64 exec, vcc
    buffer_load_dwordx4 v[16:19], v9, s[20:23], s44 offen sc1
    s_mov_b64 exec, s[96:97]
    buffer_load_dwordx4 v[20:23], v9, s[20:23], s45 offen sc1
    s_mov_b64 exec, -1
    s_add_u32 s7, s7, 1
    s_cmp_ge_u32 s7, 20000
    s_waitcnt vmcnt(0)
    s_cbranch_scc0 L_p3_chk
    s_branch L_p3_ok
L_ft:
    s_barrier
    buffer_load_dwordx4 v2, s[24:27], s8 offen nt lds
    s_add_u32 m0, m0, 0x400
    s_nop 0
    buffer_load_dwordx4 v2, s[24:27], s9 offen nt lds
    s_add_u32 m0, m0, 0x400
    s_nop 0
    buffer_load_dwordx4 v2, s[24:27], s10 offen nt lds
    s_add_u32 m0, m0, 0x400
    s_nop 0
    buffer_load_dwordx4 v2, s[24:27], s11 offen nt lds
    s_add_u32 m0, m0, 0x400
    s_nop 0
    buffer_load_dwordx4 v42, s[24:27], s8 offen nt lds
    s_add_u32 m0, m0, 0x400
    s_nop 0
    buffer_load_dwordx4 v42, s[24:27], s9 offen nt lds
    s_add_u32 m0, m0, 0x400
    s_nop 0
    buffer_load_dwordx4 v42, s[24:27], s10 offen nt lds
    s_add_u32 m0, m0, 0x400
    s_nop 0
    buffer_load_dwordx4 v42, s[24:27], s11 offen nt lds
    s_mov_b64 exec, 0x1111
    buffer_load_dword v44, v13, s[20:23], s57 offen sc1
    s_mov_b64 exec, -1
    ds_read_b32 v36, v217 offset:8560
    s_waitcnt lgkmcnt(0)
    v_cmp_eq_u32 vcc, 1, v36
    s_and_b64 s[58:59], vcc, 0xffff
    s_andn2_b64 s[60:61], 0xffff, vcc
    s_waitcnt vmcnt(5)
    ds_read_b64_tr_b16 v[80:81], v32 offset:14848
    ds_read_b64_tr_b16 v[82:83], v32 offset:15360
    ds_read_b64_tr_b16 v[84:85], v33 offset:14848
    ds_read_b64_tr_b16 v[86:87], v33 offset:15360
    ds_read_b64_tr_b16 v[88:89], v34 offset:14848
    ds_read_b64_tr_b16 v[90:91], v34 offset:15360
    ds_read_b64_tr_b16 v[92:93], v35 offset:14848
    ds_read_b64_tr_b16 v[94:95], v35 offset:15360
    s_waitcnt lgkmcnt(6)
    v_mfma_f32_16x16x32_bf16 v[120:123], v[112:115], v[80:83], 0
    s_waitcnt lgkmcnt(4)
    v_mfma_f32_16x16x32_bf16 v[124:127], v[112:115], v[84:87], 0
    s_waitcnt lgkmcnt(2)
    v_mfma_f32_16x16x32_bf16 v[128:131], v[112:115], v[88:91], 0
    s_waitcnt lgkmcnt(0)
    v_mfma_f32_16x16x32_bf16 v[132:135], v[112:115], v[92:95], 0
    s_waitcnt vmcnt(1)
    s_barrier
    ds_read_b64_tr_b16 v[96:97], v32 offset:18944
    ds_read_b64_tr_b16 v[98:99], v32 offset:19456
    ds_read_b64_tr_b16 v[100:101], v33 offset:18944
    ds_read_b64_tr_b16 v[102:103], v33 offset:19456
    ds_read_b64_tr_b16 v[104:105], v34 offset:18944
    ds_read_b64_tr_b16 v[106:107], v34 offset:19456
    ds_read_b64_tr_b16 v[108:109], v35 offset:18944
    ds_read_b64_tr_b16 v[110:111], v35 offset:19456
    s_waitcnt lgkmcnt(6)
    v_mfma_f32_16x16x32_bf16 v[120:123], v[112:115], v[96:99], v[120:123]
    s_waitcnt lgkmcnt(4)
    v_mfma_f32_16x16x32_bf16 v[124:127], v[112:115], v[100:103], v[124:127]
    s_waitcnt lgkmcnt(2)
    v_mfma_f32_16x16x32_bf16 v[128:131], v[112:115], v[104:107], v[128:131]
    s_waitcnt lgkmcnt(0)
    v_mfma_f32_16x16x32_bf16 v[132:135], v[112:115], v[108:111], v[132:135]
    s_nop 7
    v_perm_b32 v72, v120, v132, s48
    v_perm_b32 v73, v124, v132, s49
    v_perm_b32 v74, v128, v132, s50
    s_mov_b64 exec, s[58:59]
    buffer_store_dwordx4 v[72:75], v13, s[20:23], s56 offen
    s_mov_b64 exec, s[60:61]
    buffer_store_dwordx4 v[72:75], v13, s[20:23], s56 offen sc1
    s_mov_b64 exec, -1
    s_barrier
    ds_read_b128 v[112:115], v38 offset:8704
    ds_read_b128 v[116:119], v38 offset:8768
    s_waitcnt lgkmcnt(1)
    v_mfma_f32_16x16x32_bf16 v[132:135], v[112:115], v[92:95], 0
    v_mfma_f32_16x16x32_bf16 v[120:123], v[112:115], v[80:83], 0
    v_mfma_f32_16x16x32_bf16 v[124:127], v[112:115], v[84:87], 0
    v_mfma_f32_16x16x32_bf16 v[128:131], v[112:115], v[88:91], 0
    s_waitcnt lgkmcnt(0)
    v_mfma_f32_16x16x32_bf16 v[132:135], v[116:119], v[108:111], v[132:135]
    v_mfma_f32_16x16x32_bf16 v[120:123], v[116:119], v[96:99], v[120:123]
    v_mfma_f32_16x16x32_bf16 v[124:127], v[116:119], v[100:103], v[124:127]
    v_mfma_f32_16x16x32_bf16 v[128:131], v[116:119], v[104:107], v[128:131]
    s_mov_b64 exec, 0xffff
    s_cbranch_scc1 L_fa4
    s_nop 3
    v_perm_b32 v72, v120, v132, s48
    v_perm_b32 v73, v124, v132, s49
    v_perm_b32 v74, v128, v132, s50
    buffer_store_dwordx4 v[72:75], v13, s[20:23], s57 offen
    s_endpgm
L_fa4:
    s_nop 3
    v_perm_b32 v72, v120, v132, s48
    v_perm_b32 v73, v124, v132, s49
    v_perm_b32 v74, v128, v132, s50
    buffer_store_dwordx4 v[72:75], v13, s[20:23], s57 offen sc1
    s_endpgm
L_fa5:
    s_or_b32 s7, s4, s5
    s_bitcmp1_b32 s7, 0
    s_cbranch_scc0 L_fa6
    s_endpgm
L_fa6:
    v_mov_b32 v112, 0x3f803f80
    v_mov_b32 v113, 0x3f803f80
    v_mov_b32 v114, 0x3f803f80
    v_mov_b32 v115, 0x3f803f80
    v_mov_b32 v116, 0x3f803f80
    v_mov_b32 v117, 0x3f803f80
    v_mov_b32 v118, 0x3f803f80
    v_mov_b32 v119, 0x3f803f80
    v_lshrrev_b32 v11, 4, v1
    v_lshlrev_b32 v38, 4, v11
    v_mul_u32_u24 v13, 2176, v1
    s_mul_i32 s46, s3, 34816
    s_lshl3_add_u32 s46, s4, s46
    s_add_u32 s46, s46, 0xa4780
    s_mov_b64 exec, 0xffff
    buffer_load_dword v44, v13, s[20:23], s46 offen sc1
    s_and_b32 s58, s47, 0xffff
    s_andn2_b32 s60, 0xffff, s47
    s_mov_b32 s59, 0
    s_mov_b32 s61, 0
    s_mov_b32 exec_lo, 0xfffdfffd
    s_mov_b32 exec_hi, 0xfffdfffd
    s_barrier
    s_barrier
    ds_read_b128 v[112:115], v38 offset:8704
    ds_read_b128 v[116:119], v38 offset:8768
    s_mov_b64 exec, -1
    s_waitcnt lgkmcnt(1)
    v_mfma_f32_16x16x32_bf16 v[68:71], v[112:115], v[112:115], 0
    s_waitcnt lgkmcnt(0)
    v_mfma_f32_16x16x32_bf16 v[68:71], v[116:119], v[116:119], v[68:71]
    s_nop 7
    v_mov_b32_dpp v72, v68 row_newbcast:0 row_mask:0xf bank_mask:0xf
    v_mov_b32_dpp v73, v69 row_newbcast:0 row_mask:0xf bank_mask:0xf
    s_mov_b64 exec, s[58:59]
    buffer_store_dwordx4 v[72:75], v13, s[20:23], s46 offen
    s_mov_b64 exec, s[60:61]
    buffer_store_dwordx4 v[72:75], v13, s[20:23], s46 offen sc1
    s_mov_b64 exec, -1
    s_endpgm
L_fkv:
    s_cmp_ge_u32 s5, 6
    s_barrier
    s_cbranch_scc1 L_fa5
    v_lshlrev_b32 v217, 7, v1
    s_lshl_b32 s45, s3, 12
    s_add_u32 s45, s45, 0x5000
    s_mov_b32 s62, 0
    s_mov_b64 exec, 3
    buffer_load_dwordx2 v[218:219], v217, s[20:23], s45 offen offset:1824 sc1
    s_mov_b64 exec, -1
    v_and_b32 v12, 7, v1
    v_cmp_gt_u32 vcc, 7, v12
    v_min_u32 v11, 6, v12
    v_bfe_u32 v10, v1, 3, 2
    v_mul_u32_u24 v10, 1920, v10
    v_lshl_add_u32 v10, v11, 4, v10
    v_lshrrev_b32 v11, 5, v1
    v_lshl_add_u32 v9, v11, 14, v10
    v_lshrrev_b32 v11, 4, v1
    v_lshl_add_u32 v37, s55, 2, v11
    v_lshl_add_u32 v37, v37, 3, v12
    v_lshlrev_b32 v37, 1, v37
    s_and_b32 s7, s4, 14
    s_add_u32 s7, s7, s55
    s_mul_i32 s7, s7, 7
    v_add_u32 v12, s7, v12
    v_and_b32 v10, 0x77, v12
    v_and_b32 v3, 7, v12
    v_add_u32 v10, v10, v3
    v_bfe_u32 v3, v12, 3, 1
    v_add_lshl_u32 v10, v10, v3, 2
    v_add_lshl_u32 v12, v10, v11, 1
    v_cndmask_b32 v12, 2.0, v12, vcc
    v_cndmask_b32_e64 v14, 0, 1.0, vcc
    buffer_load_ushort v15, v12, s[36:39], 0 offen
    s_and_b32 s44, s2, 0
    s_lshl_b32 s44, s44, 16
    s_lshl4_add_u32 s44, s7, s44
    s_add_u32 s44, s44, 0x1a0000
L_sd_wait:
    s_waitcnt vmcnt(0)
    v_cmp_eq_u32 vcc, s6, v219
    s_and_b32 s7, vcc_lo, 3
    s_cbranch_scc0 L_sd_retry
    s_ff1_i32_b32 s7, s7
    v_readlane_b32 s7, v218, s7
    s_and_b32 s7, s7, 0x2000
    s_add_u32 s44, s44, s7
L_sd_ok:
    s_add_u32 s45, s44, 0x8000
    s_barrier
    buffer_load_dwordx4 v[16:19], v9, s[20:23], s44 offen sc1
    buffer_load_dwordx4 v[20:23], v9, s[20:23], s45 offen sc1
    s_waitcnt vmcnt(2)
    v_lshlrev_b32 v15, 16, v15
    s_mov_b32 s7, 0
    s_waitcnt vmcnt(0)
L_p1_chk:
    v_cmp_ne_u32 vcc, s6, v19
    v_cmp_ne_u32_e64 s[96:97], s6, v23
    s_or_b64 s[62:63], vcc, s[96:97]
    s_cbranch_scc1 L_p1_retry
L_p1_ok:
    v_perm_b32 v19, v17, v16, s51
    v_perm_b32 v23, v21, v20, s51
    v_perm_b32 v19, v18, v19, s52
    v_perm_b32 v23, v22, v23, s52
    v_pk_add_f32 v[16:17], v[16:17], v[20:21]
    v_pk_add_f32 v[18:19], v[18:19], v[22:23]
    s_nop 1
    v_permlane32_swap_b32 v16, v18
    v_permlane32_swap_b32 v17, v19
    v_pk_add_f32 v[16:17], v[16:17], v[18:19]
    s_nop 1
    v_permlane16_swap_b32 v16, v17
    v_add_f32 v16, v16, v17
    s_nop 1
    v_add_f32_dpp v16, v16, v16 row_ror:8 row_mask:0xf bank_mask:0xf
    v_cvt_pk_bf16_f32 v16, 0, v16
    v_fma_f32 v16, v16, v14, v15
    v_cvt_pk_bf16_f32 v16, v16, v16
    ds_write_b16 v37, v16 offset:8704
    s_waitcnt lgkmcnt(0)
    s_barrier
    s_endpgm
L_sd_retry:
    s_add_u32 s62, s62, 1
    s_cmp_ge_u32 s62, 12
    s_cbranch_scc1 L_sd_ok
    s_mov_b64 exec, 3
    buffer_load_dwordx2 v[218:219], v217, s[20:23], s45 offen offset:1824 sc1
    s_mov_b64 exec, -1
    s_branch L_sd_wait
L_p1_retry:
    s_mov_b64 exec, vcc
    buffer_load_dwordx4 v[16:19], v9, s[20:23], s44 offen sc1
    s_mov_b64 exec, s[96:97]
    buffer_load_dwordx4 v[20:23], v9, s[20:23], s45 offen sc1
    s_mov_b64 exec, -1
    s_add_u32 s7, s7, 1
    s_cmp_ge_u32 s7, 20000
    s_waitcnt vmcnt(0)
    s_cbranch_scc0 L_p1_chk
    s_branch L_p1_ok
L_d2:
    s_endpgm
L_d1:
    s_cmp_eq_u32 s3, 0
    s_cbranch_scc1 L_d2
L_d0:
    s_sub_u32 s3, s3, 1
    s_cbranch_scc1 L_d2
    s_cmp_ge_u32 s5, 4
    s_cbranch_scc0 L_d2
    s_lshl4_add_u32 s54, s3, s4
    v_lshrrev_b32 v12, 4, v1
    v_mul_u32_u24 v10, 14336, v12
    v_and_b32 v11, 15, v1
    v_lshl_add_u32 v11, s55, 4, v11
    v_lshl_add_u32 v3, v11, 4, v10
    v_cmp_gt_u32 vcc, 56, v11
    s_and_b32 s7, s54, 0x7c
    s_lshl1_add_u32 s7, s7, s7
    s_add_u32 s7, s7, s54
    v_cndmask_b32 v3, 2.0, v3, vcc
    s_mul_i32 s16, s7, 3584
    v_and_b32 v10, 0x3c0, v8
    v_add_u32 v43, v10, v8
    v_and_b32 v10, 7, v1
    v_lshlrev_b32 v40, 4, v10
    s_mul_i32 s56, s54, 2176
    s_add_u32 s56, s56, 0xa4000
    s_add_u32 s45, s56, 2048
    s_barrier
    buffer_load_dwordx4 v[176:179], v3, s[32:35], s16 offen offset:0 nt
    buffer_load_dwordx4 v[180:183], v3, s[32:35], s16 offen offset:896 nt
    buffer_load_dwordx4 v[184:187], v3, s[32:35], s16 offen offset:1792 nt
    buffer_load_dwordx4 v[188:191], v3, s[32:35], s16 offen offset:2688 nt
    v_and_b32 v10, 0x70, v8
    v_bfe_u32 v11, v1, 3, 1
    v_lshl_add_u32 v10, v11, 8, v10
    v_bfe_u32 v11, v1, 4, 1
    v_lshl_add_u32 v10, v11, 7, v10
    v_lshrrev_b32 v11, 5, v1
    v_lshl_add_u32 v41, v11, 13, v10
    s_and_b32 s57, s54, 3
    s_mul_i32 s57, s57, -2176
    s_lshl3_add_u32 s7, s54, s55
    s_lshl_b32 s7, s7, 9
    s_add_u32 s57, s57, s7
    s_add_u32 s57, s57, 0x110000
    s_cmp_eq_u32 s55, 3
    s_cselect_b32 s58, 0x00ff00ff, -1
    s_mov_b32 s59, s58
    v_mov_b32 v42, 0xc0135761
    s_mov_b32 s18, 0x3b124925
    s_mov_b32 s19, 0xbdd2d3e8
    v_mov_b32 v75, s6
    s_waitcnt vmcnt(3)
    buffer_load_dwordx4 v[24:27], v43, s[20:23], s56 offen offset:64 sc1
    s_mov_b32 s7, 0
    s_waitcnt vmcnt(0)
L_pc_chk:
    v_cmp_ne_u32 vcc, s6, v27
    s_cbranch_vccnz L_pc_retry
L_pc_ok:
    buffer_load_dwordx4 v[16:19], v43, s[20:23], s56 offen sc1
    buffer_load_dwordx4 v[36:39], v40, s[20:23], s45 offen sc1
    v_perm_b32 v27, v25, v24, s51
    v_perm_b32 v27, v26, v27, s52
    v_permlane32_swap_b32 v24, v26
    s_nop 0
    v_permlane32_swap_b32 v25, v27
    v_pk_add_f32 v[24:25], v[24:25], v[26:27]
    s_nop 1
    v_permlane16_swap_b32 v24, v25
    v_add_f32 v24, v24, v25
    s_nop 1
    v_add_f32_dpp v24, v24, v24 row_ror:8 row_mask:0xf bank_mask:0xf
    s_mov_b32 s7, 0
    s_waitcnt vmcnt(0)
L_pg_chk:
    v_cmp_ne_u32 vcc, s6, v19
    v_cmp_ne_u32_e64 s[96:97], s6, v39
    s_or_b64 s[62:63], vcc, s[96:97]
    s_cbranch_scc1 L_pg_retry
L_pg_ok:
    v_add_f32_dpp v37, v37, v37 row_ror:4 row_mask:0xf bank_mask:0xf
    v_add_f32_dpp v36, v36, v36 row_ror:4 row_mask:0xf bank_mask:0xf
    v_perm_b32 v19, v17, v16, s51
    v_add_f32_dpp v37, v37, v37 row_ror:2 row_mask:0xf bank_mask:0xf
    v_add_f32_dpp v36, v36, v36 row_ror:2 row_mask:0xf bank_mask:0xf
    v_perm_b32 v19, v18, v19, s52
    v_add_f32_dpp v37, v37, v37 row_ror:1 row_mask:0xf bank_mask:0xf
    v_add_f32_dpp v36, v36, v36 row_ror:1 row_mask:0xf bank_mask:0xf
    v_permlane32_swap_b32 v16, v18
    v_mul_f32 v37, s18, v37
    v_permlane32_swap_b32 v17, v19
    v_mul_f32 v36, s18, v36
    v_pk_add_f32 v[16:17], v[16:17], v[18:19]
    v_fma_f32 v36, -v37, v37, v36
    v_cvt_pk_bf16_f32 v37, 0, v37
    v_max_f32 v36, 0, v36
    v_permlane16_swap_b32 v16, v17
    v_cvt_pk_bf16_f32 v36, 0, v36
    v_add_f32 v16, v16, v17
    v_add_f32 v36, 0x3727c5ac, v36
    v_mul_f32 v24, v37, v24
    v_cvt_pk_bf16_f32 v36, 0, v36
    v_sqrt_f32 v36, v36
    v_add_f32_dpp v16, v16, v16 row_ror:8 row_mask:0xf bank_mask:0xf
    v_cvt_pk_bf16_f32 v36, 0, v36
    v_rcp_f32 v36, v36
    v_sub_f32 v16, v16, v24
    v_mul_f32 v16, v16, v36
    v_cvt_pk_bf16_f32 v16, 0, v16
    v_mul_f32 v22, v16, v16
    v_fmac_f32 v42, s19, v22
    v_mul_f32 v22, v42, v16
    v_exp_f32 v22, v22
    s_nop 0
    v_add_f32 v22, 1.0, v22
    v_rcp_f32 v22, v22
    s_nop 0
    v_mul_f32 v22, v16, v22
    v_cvt_pk_bf16_f32 v22, 0, v22
    s_nop 1
    v_mul_f32_dpp v22, v16, v22 row_ror:4 row_mask:0xf bank_mask:0xf
    v_cvt_pk_bf16_f32 v22, v22, v22
    s_nop 1
    v_and_b32_dpp v48, v22, v4 row_newbcast:0 row_mask:0xf bank_mask:0xf
    v_and_b32_dpp v49, v22, v5 row_newbcast:0 row_mask:0xf bank_mask:0xf
    v_and_b32_dpp v50, v22, v6 row_newbcast:0 row_mask:0xf bank_mask:0xf
    v_and_b32_dpp v51, v22, v7 row_newbcast:0 row_mask:0xf bank_mask:0xf
    v_and_b32_dpp v52, v22, v4 row_newbcast:1 row_mask:0xf bank_mask:0xf
    v_and_b32_dpp v53, v22, v5 row_newbcast:1 row_mask:0xf bank_mask:0xf
    v_mfma_f32_16x16x32_bf16 v[64:67], v[48:51], v[176:179], 0
    v_and_b32_dpp v54, v22, v6 row_newbcast:1 row_mask:0xf bank_mask:0xf
    v_and_b32_dpp v55, v22, v7 row_newbcast:1 row_mask:0xf bank_mask:0xf
    v_and_b32_dpp v56, v22, v4 row_newbcast:2 row_mask:0xf bank_mask:0xf
    v_and_b32_dpp v57, v22, v5 row_newbcast:2 row_mask:0xf bank_mask:0xf
    v_mfma_f32_16x16x32_bf16 v[64:67], v[52:55], v[180:183], v[64:67]
    v_and_b32_dpp v58, v22, v6 row_newbcast:2 row_mask:0xf bank_mask:0xf
    v_and_b32_dpp v59, v22, v7 row_newbcast:2 row_mask:0xf bank_mask:0xf
    v_and_b32_dpp v60, v22, v4 row_newbcast:3 row_mask:0xf bank_mask:0xf
    v_and_b32_dpp v61, v22, v5 row_newbcast:3 row_mask:0xf bank_mask:0xf
    v_mfma_f32_16x16x32_bf16 v[64:67], v[56:59], v[184:187], v[64:67]
    v_and_b32_dpp v62, v22, v6 row_newbcast:3 row_mask:0xf bank_mask:0xf
    v_and_b32_dpp v63, v22, v7 row_newbcast:3 row_mask:0xf bank_mask:0xf
    s_nop 1
    v_mfma_f32_16x16x32_bf16 v[64:67], v[60:63], v[188:191], v[64:67]
    s_mov_b64 exec, s[58:59]
    s_nop 6
    v_perm_b32 v72, v64, v67, s48
    v_perm_b32 v73, v65, v67, s49
    v_perm_b32 v74, v66, v67, s50
    buffer_store_dwordx4 v[72:75], v41, s[20:23], s57 offen sc1
    s_endpgm
L_pc_retry:
    s_mov_b64 exec, vcc
    buffer_load_dwordx4 v[24:27], v43, s[20:23], s56 offen offset:64 sc1
    s_mov_b64 exec, -1
    s_add_u32 s7, s7, 1
    s_cmp_ge_u32 s7, 20000
    s_waitcnt vmcnt(0)
    s_cbranch_scc0 L_pc_chk
    s_branch L_pc_ok
L_pg_retry:
    s_mov_b64 exec, vcc
    buffer_load_dwordx4 v[16:19], v43, s[20:23], s56 offen sc1
    s_mov_b64 exec, s[96:97]
    buffer_load_dwordx4 v[36:39], v40, s[20:23], s45 offen sc1
    s_mov_b64 exec, -1
    s_add_u32 s7, s7, 1
    s_cmp_ge_u32 s7, 20000
    s_waitcnt vmcnt(0)
    s_cbranch_scc0 L_pg_chk
    s_branch L_pg_ok
L_exit:
L_end:
    s_endpgm
.section .rodata,"a"
.p2align 6
.amdhsa_kernel sequential_preLN__sliding_block_cached__geglu_ffn__decode_kernel
  .amdhsa_next_free_vgpr 224
  .amdhsa_next_free_sgpr 102
  .amdhsa_accum_offset 224
  .amdhsa_group_segment_fixed_size 0
  .amdhsa_kernarg_size 96
  .amdhsa_float_denorm_mode_32 3
  .amdhsa_user_sgpr_count 2
  .amdhsa_user_sgpr_kernarg_segment_ptr 1
  .amdhsa_system_sgpr_workgroup_id_x 1
.end_amdhsa_kernel
```
